```python
import torch

def _softmax(x, axis=-1):
    return torch.softmax(x, dim=axis)
def _gelu(x):
    return torch.nn.functional.gelu(x, approximate="tanh")
def _silu(x):
    return torch.nn.functional.silu(x)
def _sigmoid(x):
    return torch.sigmoid(x)
def _layernorm(x, axis=-1, eps=1e-5):
    m = x.mean(dim=axis, keepdim=True)
    v = x.var(dim=axis, keepdim=True, unbiased=False)
    return (x - m) / torch.sqrt(v + eps)
def _scatter_add(tgt, idx, src, axis=0):
    return tgt.clone().index_add_(axis, idx, src)
def _segment_sum(src, seg, n):
    out = torch.zeros((n,) + src.shape[1:], dtype=src.dtype)
    return out.index_add_(0, seg, src)
def _pad(x, pw):
    flat = tuple(v for pair in reversed(pw) for v in pair)
    return torch.nn.functional.pad(x, flat)

kernel_name = 'gather_scatter__cheap_equivariant_egnn__graph'

def setup_inputs():

    _w = (lambda a: (lambda t: t.to(torch.bfloat16) if t.is_floating_point() else t)(torch.as_tensor(a)))
    N, deg, D, De = 50000, 16, 64, max(0, 1)
    E = N * deg
    return {
        "h": _w((lambda *s: torch.randn(*s, dtype=torch.bfloat16) * 0.2)(N, D)),
        "pos": _w((lambda *s: torch.randn(*s, dtype=torch.bfloat16) * 0.4)(N, 3)),
        "e_attr": _w((lambda *s: torch.randn(*s, dtype=torch.bfloat16) * 0.4)(E, De)),
        "src": _w((lambda lo, hi, *s: torch.randint(lo, hi, s))(0, N, E).to(torch.int64)),
        "dst": _w((lambda lo, hi, *s: torch.randint(lo, hi, s))(0, N, E).to(torch.int64)),
        "w_e": _w(0.1 * (lambda *s: torch.randn(*s, dtype=torch.bfloat16) * 0.4)(2 * D + 1 + De, D)),
        "w_x": _w(0.1 * (lambda *s: torch.randn(*s, dtype=torch.bfloat16) * 0.2)(D, 1)),
        "w_h": _w(0.1 * (lambda *s: torch.randn(*s, dtype=torch.bfloat16) * 0.2)(2 * D, D)),
    }

def reference(h, pos, e_attr, src, dst, w_e, w_x, w_h):
    N, D = h.shape[0], h.shape[1]
    diff = pos[dst] - pos[src]
    dist2 = torch.sum(diff * diff, axis=-1, keepdims=True)
    e_in = torch.concatenate([h[dst], h[src], dist2, e_attr], axis=-1)
    m_ij = _silu(e_in @ w_e)
    coord_scale = m_ij @ w_x
    pos_new = pos + _segment_sum(diff * coord_scale, dst, N)
    m_i = _segment_sum(m_ij, dst, N)
    h_new = h + _silu(torch.concatenate([h, m_i], axis=-1) @ w_h)
    return h_new, pos_new
```

```asm
; @launch grid=(256,1,1) block=(512,1,1) lds=160992
.amdgcn_target "amdgcn-amd-amdhsa--gfx950"
.text
    .globl gather_scatter__cheap_equivariant_egnn__graph_kernel
    .p2align 8
    .type gather_scatter__cheap_equivariant_egnn__graph_kernel,@function
gather_scatter__cheap_equivariant_egnn__graph_kernel:
    s_cmp_ge_u32 s2, 256
    s_cbranch_scc1 K2_end
    s_load_dwordx8 s[8:15], s[0:1], 8
    s_load_dwordx2 s[16:17], s[0:1], 80
    s_getpc_b64 s[50:51]
    v_lshlrev_b32 v100, 7, v0
    v_cmp_gt_u32 vcc, 192, v0
    s_mov_b64 exec, vcc
    s_cbranch_execz KM_npf3
    global_load_dword v101, v100, s[50:51]
KM_npf3:
    s_mov_b64 exec, -1
    v_lshrrev_b32 v1, 6, v0
    s_mul_i32 s18, s2, 3128
    v_readfirstlane_b32 s33, v1
    s_sub_u32 s19, 800000, s18
    s_min_u32 s19, s19, 3128
    s_cmp_eq_u32 s33, 7
    s_cbranch_scc1 KM_help
    s_lshr_b32 s19, s19, 3
    v_lshlrev_b32 v3, 3, v0
    v_add_u32 v3, s18, v3
    v_lshlrev_b32 v4, 2, v3
    v_lshlrev_b32 v5, 1, v3
    v_cmp_gt_u32 vcc, s19, v0
    s_mov_b64 s[48:49], vcc
    s_mov_b32 s22, 3200000
    s_mov_b32 s23, 0x20000
    s_mov_b64 exec, s[48:49]
    s_waitcnt lgkmcnt(0)
    s_mov_b32 s20, s14
    s_mov_b32 s21, s15
    s_cbranch_execz KM_l1
    buffer_load_dwordx4 v[12:15], v4, s[20:23], 0 offen
    buffer_load_dwordx4 v[16:19], v4, s[20:23], 0 offen offset:16
KM_l1:
    s_mov_b64 exec, -1
    s_mov_b32 s24, s12
    s_mov_b32 s25, s13
    s_mov_b32 s26, 3200000
    s_mov_b32 s27, 0x20000
    s_mov_b32 s28, s10
    s_mov_b32 s29, s11
    s_mov_b32 s30, 1600000
    s_mov_b32 s31, 0x20000
    v_lshlrev_b32 v1, 2, v0
    v_mov_b32 v2, 0
    v_cmp_gt_u32 vcc, 256, v0
    s_and_saveexec_b64 s[40:41], vcc
    ds_write_b32 v1, v2
    s_mov_b64 exec, s[40:41]
    s_mov_b32 s35, 85599
    v_mov_b32 v10, 1
    s_mov_b32 s36, 0xffff0000
    s_movk_i32 s37, -196
    s_mul_i32 s38, s2, 27264
    s_add_u32 s44, s16, s38
    s_addc_u32 s45, s17, 0
    s_mov_b32 s47, 0x20000
    s_mov_b32 s56, s16
    s_mov_b32 s57, s17
    s_mov_b32 s58, 14811136
    s_mov_b32 s59, 0x20000
    s_waitcnt lgkmcnt(0)
    s_barrier
    s_mov_b64 exec, s[48:49]
    s_cbranch_execz KM_l2
    buffer_load_dwordx4 v[20:23], v4, s[24:27], 0 offen
    buffer_load_dwordx4 v[24:27], v4, s[24:27], 0 offen offset:16
    buffer_load_dwordx4 v[28:31], v5, s[28:31], 0 offen
KM_l2:
    s_mov_b64 exec, s[48:49]
    s_cbranch_execz KM_r1
    s_waitcnt vmcnt(4)
    v_mul_u32_u24 v56, s35, v12
    v_lshrrev_b32 v56, 24, v56
    v_mad_i32_i24 v12, v56, s37, v12
    v_lshlrev_b32 v56, 2, v56
    ds_add_rtn_u32 v64, v56, v10
    v_mul_u32_u24 v57, s35, v13
    v_lshrrev_b32 v57, 24, v57
    v_mad_i32_i24 v13, v57, s37, v13
    v_lshlrev_b32 v57, 2, v57
    ds_add_rtn_u32 v65, v57, v10
    v_mul_u32_u24 v58, s35, v14
    v_lshrrev_b32 v58, 24, v58
    v_mad_i32_i24 v14, v58, s37, v14
    v_lshlrev_b32 v58, 2, v58
    ds_add_rtn_u32 v66, v58, v10
    v_mul_u32_u24 v59, s35, v15
    v_lshrrev_b32 v59, 24, v59
    v_mad_i32_i24 v15, v59, s37, v15
    v_lshlrev_b32 v59, 2, v59
    ds_add_rtn_u32 v67, v59, v10
    s_waitcnt vmcnt(3)
    v_mul_u32_u24 v60, s35, v16
    v_lshrrev_b32 v60, 24, v60
    v_mad_i32_i24 v16, v60, s37, v16
    v_lshlrev_b32 v60, 2, v60
    ds_add_rtn_u32 v68, v60, v10
    v_mul_u32_u24 v61, s35, v17
    v_lshrrev_b32 v61, 24, v61
    v_mad_i32_i24 v17, v61, s37, v17
    v_lshlrev_b32 v61, 2, v61
    ds_add_rtn_u32 v69, v61, v10
    v_mul_u32_u24 v62, s35, v18
    v_lshrrev_b32 v62, 24, v62
    v_mad_i32_i24 v18, v62, s37, v18
    v_lshlrev_b32 v62, 2, v62
    ds_add_rtn_u32 v70, v62, v10
    v_mul_u32_u24 v63, s35, v19
    v_lshrrev_b32 v63, 24, v63
    v_mad_i32_i24 v19, v63, s37, v19
    v_lshlrev_b32 v63, 2, v63
    ds_add_rtn_u32 v71, v63, v10
    v_lshlrev_b32 v12, 1, v12
    v_lshlrev_b32 v13, 1, v13
    v_lshlrev_b32 v14, 1, v14
    v_lshlrev_b32 v15, 1, v15
    v_lshlrev_b32 v16, 1, v16
    v_lshlrev_b32 v17, 1, v17
    v_lshlrev_b32 v18, 1, v18
    v_lshlrev_b32 v19, 1, v19
KM_r1:
    s_mov_b64 exec, -1
    s_waitcnt lgkmcnt(0)
    s_barrier
    v_and_b32 v38, 63, v0
    v_lshlrev_b32 v39, 4, v38
    ds_read_b128 v[40:43], v39
    s_waitcnt lgkmcnt(0)
    v_add_u32 v52, 1, v40
    v_add_u32 v53, 1, v41
    v_add_u32 v54, 1, v42
    v_add_u32 v55, 1, v43
    v_and_b32 v52, -2, v52
    v_and_b32 v53, -2, v53
    v_and_b32 v54, -2, v54
    v_and_b32 v55, -2, v55
    v_add_u32 v44, v52, v53
    v_add_u32 v45, v44, v54
    v_add_u32 v46, v45, v55
    v_mov_b32 v47, v46
    s_nop 1
    v_add_u32_dpp v47, v47, v47 row_shr:1 row_mask:0xf bank_mask:0xf bound_ctrl:0
    s_nop 1
    v_add_u32_dpp v47, v47, v47 row_shr:2 row_mask:0xf bank_mask:0xf bound_ctrl:0
    s_nop 1
    v_add_u32_dpp v47, v47, v47 row_shr:4 row_mask:0xf bank_mask:0xf bound_ctrl:0
    s_nop 1
    v_add_u32_dpp v47, v47, v47 row_shr:8 row_mask:0xf bank_mask:0xf bound_ctrl:0
    s_nop 1
    v_add_u32_dpp v47, v47, v47 row_bcast:15 row_mask:0xa bank_mask:0xf
    s_nop 1
    v_add_u32_dpp v47, v47, v47 row_bcast:31 row_mask:0xc bank_mask:0xf
    v_sub_u32 v48, v47, v46
    v_add_u32 v48, 7104, v48
    v_add_u32 v49, v48, v52
    v_add_u32 v50, v48, v44
    v_add_u32 v51, v48, v45
    ds_write_b128 v39, v[48:51] offset:1024
    v_readlane_b32 s46, v47, 63
    s_mov_b64 exec, s[48:49]
    s_cbranch_execz KM_p1
    ds_read_b32 v56, v56 offset:1024
    ds_read_b32 v57, v57 offset:1024
    ds_read_b32 v58, v58 offset:1024
    ds_read_b32 v59, v59 offset:1024
    ds_read_b32 v60, v60 offset:1024
    ds_read_b32 v61, v61 offset:1024
    ds_read_b32 v62, v62 offset:1024
    ds_read_b32 v63, v63 offset:1024
    s_waitcnt vmcnt(0)
    v_lshl_or_b32 v73, v28, 16, v12
    v_mov_b32 v72, v20
    v_and_or_b32 v75, v28, s36, v13
    v_mov_b32 v74, v21
    v_lshl_or_b32 v77, v29, 16, v14
    v_mov_b32 v76, v22
    v_and_or_b32 v79, v29, s36, v15
    v_mov_b32 v78, v23
    v_lshl_or_b32 v81, v30, 16, v16
    v_mov_b32 v80, v24
    v_and_or_b32 v83, v30, s36, v17
    v_mov_b32 v82, v25
    v_lshl_or_b32 v85, v31, 16, v18
    v_mov_b32 v84, v26
    v_and_or_b32 v87, v31, s36, v19
    v_mov_b32 v86, v27
    s_waitcnt lgkmcnt(7)
    v_add_lshl_u32 v56, v56, v64, 3
    ds_write_b64 v56, v[72:73]
    s_waitcnt lgkmcnt(7)
    v_add_lshl_u32 v57, v57, v65, 3
    ds_write_b64 v57, v[74:75]
    s_waitcnt lgkmcnt(7)
    v_add_lshl_u32 v58, v58, v66, 3
    ds_write_b64 v58, v[76:77]
    s_waitcnt lgkmcnt(7)
    v_add_lshl_u32 v59, v59, v67, 3
    ds_write_b64 v59, v[78:79]
    s_waitcnt lgkmcnt(7)
    v_add_lshl_u32 v60, v60, v68, 3
    ds_write_b64 v60, v[80:81]
    s_waitcnt lgkmcnt(7)
    v_add_lshl_u32 v61, v61, v69, 3
    ds_write_b64 v61, v[82:83]
    s_waitcnt lgkmcnt(7)
    v_add_lshl_u32 v62, v62, v70, 3
    ds_write_b64 v62, v[84:85]
    s_waitcnt lgkmcnt(7)
    v_add_lshl_u32 v63, v63, v71, 3
    ds_write_b64 v63, v[86:87]
KM_p1:
    s_mov_b64 exec, -1
    s_lshl_b32 s46, s46, 3
    v_mov_b32 v8, 2080
    v_lshlrev_b32 v4, 4, v0
    v_add_u32 v5, 56832, v4
    s_waitcnt lgkmcnt(0)
    s_barrier
    ds_read_b64 v[8:9], v8
    ds_read_b128 v[12:15], v5 offset:0
    ds_read_b128 v[16:19], v5 offset:7168
    ds_read_b128 v[20:23], v5 offset:14336
    ds_read_b128 v[24:27], v5 offset:21504
    s_waitcnt lgkmcnt(4)
    v_readfirstlane_b32 s52, v8
    v_readfirstlane_b32 s53, v9
    s_nop 3
    s_lshl_b32 s40, s52, 16
    s_lshr_b32 s41, s52, 7
    s_and_b32 s41, s41, 0xfe00
    s_mul_i32 s43, s52, 0x9e3779b1
    s_add_u32 s43, s43, s53
    s_and_b32 s42, s43, 0xffff0000
    s_and_b32 s43, s43, 0xfe00
    s_waitcnt lgkmcnt(3)
    v_or_b32 v12, s40, v12
    v_or_b32 v13, s41, v13
    v_or_b32 v14, s42, v14
    v_or_b32 v15, s43, v15
    buffer_store_dwordx4 v[12:15], v4, s[44:47], 0 offen sc1
    s_waitcnt lgkmcnt(2)
    v_or_b32 v16, s40, v16
    v_or_b32 v17, s41, v17
    v_or_b32 v18, s42, v18
    v_or_b32 v19, s43, v19
    v_add_u32 v4, 7168, v4
    buffer_store_dwordx4 v[16:19], v4, s[44:47], 0 offen sc1
    s_waitcnt lgkmcnt(1)
    v_or_b32 v20, s40, v20
    v_or_b32 v21, s41, v21
    v_or_b32 v22, s42, v22
    v_or_b32 v23, s43, v23
    v_add_u32 v4, 7168, v4
    buffer_store_dwordx4 v[20:23], v4, s[44:47], 0 offen sc1
    s_waitcnt lgkmcnt(0)
    v_or_b32 v24, s40, v24
    v_or_b32 v25, s41, v25
    v_or_b32 v26, s42, v26
    v_or_b32 v27, s43, v27
    v_add_u32 v4, 7168, v4
    buffer_store_dwordx4 v[24:27], v4, s[44:47], 0 offen sc1
    s_branch KM_p2
KM_help:
    s_load_dwordx2 s[26:27], s[0:1], 72
    s_memrealtime s[52:53]
    s_load_dwordx4 s[20:23], s[0:1], 40
    s_load_dwordx2 s[24:25], s[0:1], 56
    v_and_b32 v0, 63, v0
    v_mov_b32 v64, 0
    s_waitcnt lgkmcnt(0)
    s_mov_b32 s56, s26
    s_mov_b32 s57, s27
    s_mov_b32 s58, 256
    s_mov_b32 s59, 0x20000
    s_cmp_lg_u32 s2, 0
    s_cbranch_scc1 KM_nopub
    s_or_b32 s52, s52, 1
    s_and_b32 s40, s53, 15
    s_lshl_b32 s40, s40, 12
    s_lshr_b32 s41, s53, 4
    s_lshl_b32 s41, s41, 28
    s_or_b32 s53, s40, s41
    v_mov_b32 v62, s52
    v_mov_b32 v63, s53
    v_cmp_eq_u32 vcc, 0, v0
    s_mov_b64 exec, vcc
    buffer_store_dwordx2 v[62:63], v64, s[56:59], 0 offen sc1
    s_mov_b64 exec, -1
KM_nopub:
    buffer_load_dwordx2 v[62:63], v64, s[56:59], 0 offen sc1
    s_mov_b32 s44, s16
    s_mov_b32 s45, s17
    s_mov_b32 s46, 14811136
    s_mov_b32 s47, 0x20000
    s_and_b32 s40, s2, 31
    s_lshr_b32 s41, s2, 5
    s_mov_b32 s60, 0
    s_cmp_lt_u32 s40, 8
    s_cbranch_scc1 KM_job
    s_cmp_lg_u32 s41, 7
    s_cbranch_scc1 KM_nojob
    s_cmp_ge_u32 s40, 12
    s_cbranch_scc1 KM_nojob
    s_mov_b32 s60, 1
    s_sub_u32 s40, s40, 8
    s_lshl_b32 s40, s40, 6
    v_add_u32 v0, s40, v0
    s_mov_b32 s28, s20
    s_mov_b32 s29, s21
    s_mov_b32 s30, 16640
    s_mov_b32 s31, 0x20000
    s_mov_b32 s36, s22
    s_mov_b32 s37, s23
    s_mov_b32 s38, 128
    s_mov_b32 s39, 0x20000
    v_lshrrev_b32 v20, 4, v0
    v_bfe_u32 v21, v0, 3, 1
    v_and_b32 v23, 1, v0
    v_bfe_u32 v22, v0, 1, 2
    v_lshlrev_b32 v25, 5, v21
    v_lshl_add_u32 v25, v23, 1, v25
    v_lshl_add_u32 v25, v22, 3, v25
    v_lshl_add_u32 v25, v20, 2, v25
    v_lshlrev_b32 v25, 1, v25
    buffer_load_dword v26, v25, s[36:39], 0 offen
    v_lshlrev_b32 v27, 2, v0
    v_add_u32 v27, 7110656, v27
    v_lshrrev_b32 v28, 5, v0
    v_and_b32 v29, 31, v0
    v_lshlrev_b32 v30, 2, v29
    v_add_u32 v31, 128, v28
    v_lshl_add_u32 v31, v31, 7, v30
    buffer_load_dword v32, v31, s[28:31], 0 offen
    s_barrier
    s_waitcnt vmcnt(0)
    buffer_load_dwordx2 v[66:67], v64, s[56:59], 0 offen sc1
    s_mov_b32 s60, 2
    v_cmp_gt_u32 vcc, 32, v0
    s_mov_b64 exec, vcc
    buffer_store_dword v26, v27, s[44:47], 0 offen sc1
    s_mov_b64 exec, -1
    s_mov_b32 s40, 3216550459
    v_lshlrev_b32 v33, 16, v32
    v_and_b32 v34, 0xffff0000, v32
    v_mul_f32 v33, s40, v33
    v_mul_f32 v34, s40, v34
    v_cvt_pk_bf16_f32 v33, v33, v34
    v_lshlrev_b32 v35, 2, v0
    v_add_u32 v35, 7114752, v35
    buffer_store_dword v33, v35, s[44:47], 0 offen sc1
    s_branch KM_jobdone
KM_job:
    s_mov_b32 s60, 1
    s_lshl_b32 s41, s41, 7
    s_and_b32 s42, s40, 1
    s_lshl_b32 s42, s42, 6
    s_add_u32 s41, s41, s42
    v_add_u32 v0, s41, v0
    s_lshr_b32 s40, s40, 1
    s_mov_b32 s28, s20
    s_mov_b32 s29, s21
    s_mov_b32 s30, 16640
    s_mov_b32 s31, 0x20000
    s_mov_b32 s32, s24
    s_mov_b32 s33, s25
    s_mov_b32 s34, 16384
    s_mov_b32 s35, 0x20000
    v_lshrrev_b32 v1, 7, v0
    v_bfe_u32 v2, v0, 1, 6
    v_and_b32 v3, 3, v1
    v_lshrrev_b32 v4, 2, v1
    v_lshrrev_b32 v5, 5, v2
    v_and_b32 v6, 31, v2
    v_and_b32 v7, 1, v0
    v_lshl_add_u32 v8, v4, 5, v6
    v_lshlrev_b32 v8, 1, v8
    v_lshlrev_b32 v9, 4, v3
    v_lshl_add_u32 v10, v5, 3, v9
    v_lshl_add_u32 v10, v7, 2, v10
    v_lshl_add_u32 v11, v7, 3, v9
    v_lshl_add_u32 v11, v5, 2, v11
    v_lshlrev_b32 v12, 3, v0
    s_cmp_lg_u32 s40, 0
    s_cbranch_scc1 KM_j0n
    v_add_u32 v13, 0, v11
    v_lshl_add_u32 v13, v13, 7, v8
    buffer_load_ushort v14, v13, s[28:31], 0 offen offset:0
    buffer_load_ushort v15, v13, s[28:31], 0 offen offset:128
    buffer_load_ushort v16, v13, s[28:31], 0 offen offset:256
    buffer_load_ushort v17, v13, s[28:31], 0 offen offset:384
    s_barrier
    s_waitcnt vmcnt(0)
    buffer_load_dwordx2 v[66:67], v64, s[56:59], 0 offen sc1
    s_mov_b32 s40, 3216550459
    v_lshlrev_b32 v14, 16, v14
    v_mul_f32 v14, s40, v14
    v_lshlrev_b32 v15, 16, v15
    v_mul_f32 v15, s40, v15
    v_lshlrev_b32 v16, 16, v16
    v_mul_f32 v16, s40, v16
    v_lshlrev_b32 v17, 16, v17
    v_mul_f32 v17, s40, v17
    v_cvt_pk_bf16_f32 v18, v14, v15
    v_cvt_pk_bf16_f32 v19, v16, v17
    v_add_u32 v12, 7102464, v12
    buffer_store_dwordx2 v[18:19], v12, s[44:47], 0 offen sc1
    s_branch KM_jobdone
KM_j0n:
    s_cmp_lg_u32 s40, 1
    s_cbranch_scc1 KM_j1n
    v_add_u32 v13, 0, v11
    v_lshl_add_u32 v13, v13, 7, v8
    buffer_load_ushort v14, v13, s[32:35], 0 offen offset:0
    buffer_load_ushort v15, v13, s[32:35], 0 offen offset:128
    buffer_load_ushort v16, v13, s[32:35], 0 offen offset:256
    buffer_load_ushort v17, v13, s[32:35], 0 offen offset:384
    s_barrier
    s_waitcnt vmcnt(0)
    buffer_load_dwordx2 v[66:67], v64, s[56:59], 0 offen sc1
    s_mov_b32 s40, 3216550459
    v_lshlrev_b32 v14, 16, v14
    v_mul_f32 v14, s40, v14
    v_lshlrev_b32 v15, 16, v15
    v_mul_f32 v15, s40, v15
    v_lshlrev_b32 v16, 16, v16
    v_mul_f32 v16, s40, v16
    v_lshlrev_b32 v17, 16, v17
    v_mul_f32 v17, s40, v17
    v_cvt_pk_bf16_f32 v18, v14, v15
    v_cvt_pk_bf16_f32 v19, v16, v17
    v_add_u32 v12, 7118848, v12
    buffer_store_dwordx2 v[18:19], v12, s[44:47], 0 offen sc1
    s_branch KM_jobdone
KM_j1n:
    s_cmp_lg_u32 s40, 2
    s_cbranch_scc1 KM_j2n
    v_add_u32 v13, 64, v10
    v_lshl_add_u32 v13, v13, 7, v8
    buffer_load_ushort v14, v13, s[32:35], 0 offen offset:0
    buffer_load_ushort v15, v13, s[32:35], 0 offen offset:128
    buffer_load_ushort v16, v13, s[32:35], 0 offen offset:256
    buffer_load_ushort v17, v13, s[32:35], 0 offen offset:384
    s_barrier
    s_waitcnt vmcnt(0)
    buffer_load_dwordx2 v[66:67], v64, s[56:59], 0 offen sc1
    v_lshl_or_b32 v18, v15, 16, v14
    v_lshl_or_b32 v19, v17, 16, v16
    v_add_u32 v12, 7127040, v12
    buffer_store_dwordx2 v[18:19], v12, s[44:47], 0 offen sc1
    s_branch KM_jobdone
KM_j2n:
    v_add_u32 v13, 64, v10
    v_lshl_add_u32 v13, v13, 7, v8
    buffer_load_ushort v14, v13, s[28:31], 0 offen offset:0
    buffer_load_ushort v15, v13, s[28:31], 0 offen offset:128
    buffer_load_ushort v16, v13, s[28:31], 0 offen offset:256
    buffer_load_ushort v17, v13, s[28:31], 0 offen offset:384
    s_barrier
    s_waitcnt vmcnt(0)
    buffer_load_dwordx2 v[66:67], v64, s[56:59], 0 offen sc1
    s_mov_b32 s40, 3216550459
    v_lshlrev_b32 v14, 16, v14
    v_mul_f32 v14, s40, v14
    v_lshlrev_b32 v15, 16, v15
    v_mul_f32 v15, s40, v15
    v_lshlrev_b32 v16, 16, v16
    v_mul_f32 v16, s40, v16
    v_lshlrev_b32 v17, 16, v17
    v_mul_f32 v17, s40, v17
    v_cvt_pk_bf16_f32 v18, v14, v15
    v_cvt_pk_bf16_f32 v19, v16, v17
    v_add_u32 v12, 7094272, v12
    buffer_store_dwordx2 v[18:19], v12, s[44:47], 0 offen sc1
    s_branch KM_jobdone
KM_nojob:
    s_barrier
    s_waitcnt vmcnt(0)
    buffer_load_dwordx2 v[66:67], v64, s[56:59], 0 offen sc1
KM_jobdone:
KM_b2:
    s_barrier
    v_mbcnt_lo_u32_b32 v0, -1, 0
    v_mbcnt_hi_u32_b32 v0, -1, v0
    v_and_b32 v38, 63, v0
    v_lshlrev_b32 v39, 4, v38
    ds_read_b128 v[40:43], v39
    s_waitcnt lgkmcnt(0)
    v_add_u32 v52, 1, v40
    v_add_u32 v53, 1, v41
    v_add_u32 v54, 1, v42
    v_add_u32 v55, 1, v43
    v_and_b32 v52, -2, v52
    v_and_b32 v53, -2, v53
    v_and_b32 v54, -2, v54
    v_and_b32 v55, -2, v55
    v_add_u32 v44, v52, v53
    v_add_u32 v45, v44, v54
    v_add_u32 v46, v45, v55
    v_mov_b32 v47, v46
    s_nop 1
    v_add_u32_dpp v47, v47, v47 row_shr:1 row_mask:0xf bank_mask:0xf bound_ctrl:0
    s_nop 1
    v_add_u32_dpp v47, v47, v47 row_shr:2 row_mask:0xf bank_mask:0xf bound_ctrl:0
    s_nop 1
    v_add_u32_dpp v47, v47, v47 row_shr:4 row_mask:0xf bank_mask:0xf bound_ctrl:0
    s_nop 1
    v_add_u32_dpp v47, v47, v47 row_shr:8 row_mask:0xf bank_mask:0xf bound_ctrl:0
    s_nop 1
    v_add_u32_dpp v47, v47, v47 row_bcast:15 row_mask:0xa bank_mask:0xf
    s_nop 1
    v_add_u32_dpp v47, v47, v47 row_bcast:31 row_mask:0xc bank_mask:0xf
    v_sub_u32 v48, v47, v46
    v_add_u32 v49, v48, v52
    v_add_u32 v50, v48, v44
    v_add_u32 v51, v48, v45
    v_mov_b32 v60, 0
    v_mov_b32 v61, 0
    v_add_lshl_u32 v52, v48, v40, 3
    v_and_b32 v56, 1, v40
    v_cmp_eq_u32 vcc, 1, v56
    s_mov_b64 exec, vcc
    ds_write_b64 v52, v[60:61] offset:56832
    s_mov_b64 exec, -1
    v_add_lshl_u32 v53, v49, v41, 3
    v_and_b32 v56, 1, v41
    v_cmp_eq_u32 vcc, 1, v56
    s_mov_b64 exec, vcc
    ds_write_b64 v53, v[60:61] offset:56832
    s_mov_b64 exec, -1
    v_add_lshl_u32 v54, v50, v42, 3
    v_and_b32 v56, 1, v42
    v_cmp_eq_u32 vcc, 1, v56
    s_mov_b64 exec, vcc
    ds_write_b64 v54, v[60:61] offset:56832
    s_mov_b64 exec, -1
    v_add_lshl_u32 v55, v51, v43, 3
    v_and_b32 v56, 1, v43
    v_cmp_eq_u32 vcc, 1, v56
    s_mov_b64 exec, vcc
    ds_write_b64 v55, v[60:61] offset:56832
    s_mov_b64 exec, -1
    v_readfirstlane_b32 s52, v62
    v_readfirstlane_b32 s53, v63
    s_nop 3
    s_cmp_lg_u32 s52, 0
    s_cbranch_scc1 KM_tagok
    s_cmp_eq_u32 s60, 1
    s_cbranch_scc1 KM_w1
    s_cmp_eq_u32 s60, 2
    s_cbranch_scc1 KM_w2
    s_waitcnt vmcnt(0)
KM_w1:
    s_waitcnt vmcnt(1)
KM_w2:
    s_waitcnt vmcnt(2)
    v_mov_b32 v62, v66
    v_mov_b32 v63, v67
    v_readfirstlane_b32 s52, v66
    v_readfirstlane_b32 s53, v67
    s_nop 3
    s_mov_b32 s61, 200000
KM_tagpoll:
    s_cmp_lg_u32 s52, 0
    s_cbranch_scc1 KM_tagok
    s_sub_u32 s61, s61, 1
    s_cbranch_scc1 KM_tagok
    buffer_load_dwordx2 v[62:63], v64, s[56:59], 0 offen sc1
    s_waitcnt vmcnt(0)
    v_readfirstlane_b32 s52, v62
    v_readfirstlane_b32 s53, v63
    s_nop 3
    s_branch KM_tagpoll
KM_tagok:
    v_mov_b32 v64, 2080
    ds_write_b64 v64, v[62:63]
    v_lshl_or_b32 v212, v40, 16, v48
    v_or_b32 v212, s53, v212
    v_mov_b32 v213, s52
    v_lshl_or_b32 v214, v41, 16, v49
    v_or_b32 v214, s53, v214
    v_mov_b32 v215, s52
    v_lshl_or_b32 v216, v42, 16, v50
    v_or_b32 v216, s53, v216
    v_mov_b32 v217, s52
    v_lshl_or_b32 v218, v43, 16, v51
    v_or_b32 v218, s53, v218
    v_mov_b32 v219, s52
    v_lshlrev_b32 v56, 5, v0
    s_mul_i32 s40, s2, 2176
    s_add_u32 s40, s40, 7340032
    s_cmp_lg_u32 s60, 0
    s_cbranch_scc1 KM_late
    buffer_store_dwordx4 v[212:215], v56, s[44:47], s40 offen sc1
    buffer_store_dwordx4 v[216:219], v56, s[44:47], s40 offen offset:16 sc1
KM_late:
    s_waitcnt lgkmcnt(0)
    s_barrier
    s_cmp_eq_u32 s60, 0
    s_cbranch_scc1 KM_pub
    s_waitcnt vmcnt(0)
    buffer_store_dwordx4 v[212:215], v56, s[44:47], s40 offen sc1
    buffer_store_dwordx4 v[216:219], v56, s[44:47], s40 offen offset:16 sc1
KM_pub:
    v_add_u32 v0, 448, v0
KM_p2:
    s_load_dwordx2 s[44:45], s[0:1], 80
    s_load_dwordx2 s[100:101], s[0:1], 0
    s_load_dwordx2 s[42:43], s[0:1], 64
    s_load_dwordx2 s[32:33], s[0:1], 8
    v_and_b32 v1, 63, v0
    v_lshrrev_b32 v20, 6, v0
    s_and_b32 s28, s2, 7
    s_lshr_b32 s29, s2, 3
    v_readfirstlane_b32 s16, v20
    s_lshl_b32 s28, s28, 5
    s_add_u32 s98, s28, s29
    v_lshrrev_b32 v20, 4, v1
    v_lshrrev_b32 v22, 3, v1
    v_lshlrev_b32 v23, 2, v22
    s_lshl_b32 s28, s16, 7
    v_add_u32 v23, s28, v23
    v_lshlrev_b32 v23, 8, v23
    s_lshl_b32 s29, s98, 2
    s_add_u32 s29, s29, 6422528
    s_mul_i32 s38, s98, 196
    s_lshl_b32 s28, s16, 5
    s_add_u32 s28, s28, s38
    v_lshrrev_b32 v25, 3, v1
    v_add_u32 v250, s28, v25
    v_add_u32 v252, 8, v250
    v_add_u32 v254, 16, v250
    v_add_u32 v6, 24, v250
    s_mov_b32 s28, 49999
    v_min_u32 v250, s28, v250
    v_min_u32 v252, s28, v252
    v_min_u32 v254, s28, v254
    v_min_u32 v6, s28, v6
    v_and_b32 v24, 7, v1
    v_xor_b32 v24, v24, v20
    v_lshlrev_b32 v24, 4, v24
    v_xor_b32 v25, 64, v24
    v_add_u32 v251, 3072, v24
    v_add_u32 v253, 2048, v25
    v_add_u32 v255, 1024, v24
    v_mov_b32 v7, v25
    v_lshlrev_b32 v31, 4, v1
    s_mul_i32 s73, s16, 4352
    s_add_u32 s73, s73, 85760
    s_cmp_eq_u32 s16, 7
    s_cselect_b32 s73, 28672, s73
    s_lshl_b32 s72, s16, 10
    s_waitcnt lgkmcnt(0)
    s_mov_b32 s8, s44
    s_mov_b32 s9, s45
    s_mov_b32 s10, 14811136
    s_mov_b32 s11, 0x20000
    s_sub_u32 s4, s100, 3072
    s_subb_u32 s5, s101, 0
    s_or_b32 s5, s5, 8388608
    s_mov_b32 s6, 50000
    s_mov_b32 s7, 0x20000
    v_lshlrev_b32 v21, 4, v0
    v_mov_b32 v24, 0
    v_mov_b32 v25, 0
    v_mov_b32 v26, 0
    v_mov_b32 v27, 0
    ds_write_b128 v21, v[24:27] offset:32768
    ds_write_b128 v21, v[24:27] offset:40960
    v_add_u32 v22, 117248, v21
    ds_write_b128 v22, v[24:27] offset:0
    ds_write_b128 v22, v[24:27] offset:8192
    ds_write_b128 v22, v[24:27] offset:16384
    v_cmp_gt_u32 vcc, 256, v0
    s_and_saveexec_b64 s[34:35], vcc
    ds_write_b128 v21, v[24:27] offset:49152
    s_mov_b64 exec, s[34:35]
    v_cmp_gt_u32 vcc, 406, v0
    s_and_saveexec_b64 s[34:35], vcc
    ds_write_b128 v22, v[24:27] offset:24576
    s_mov_b64 exec, s[34:35]
    v_mov_b32 v24, -1
    v_add_u32 v22, 148320, v21
    v_cmp_gt_u32 vcc, 204, v0
    s_and_saveexec_b64 s[34:35], vcc
    ds_write_b128 v22, v[24:27]
    s_mov_b64 exec, s[34:35]
    v_lshlrev_b32 v21, 4, v0
    v_mov_b32 v24, 0
    v_mov_b32 v25, 0
    v_mov_b32 v26, 0
    v_mov_b32 v27, 0
    v_cmp_gt_u32 vcc, 129, v0
    s_and_saveexec_b64 s[34:35], vcc
    ds_write_b128 v21, v[24:27]
    s_mov_b64 exec, s[34:35]
    s_sub_u32 s37, 50000, s38
    s_min_u32 s37, s37, 196
    s_mov_b32 s30, 0
    s_mov_b32 s31, -1
    s_mov_b32 s12, s42
    s_mov_b32 s13, s43
    s_mov_b32 s14, 6700000
    s_mov_b32 s15, 0x20000
    v_and_b32 v28, 31, v1
    v_lshrrev_b32 v29, 5, v1
    s_lshl_b32 s39, s16, 12
    v_bfe_u32 v24, v28, 1, 3
    v_lshlrev_b32 v25, 4, v24
    v_lshl_add_u32 v25, v28, 7, v25
    v_lshl_add_u32 v30, v29, 3, v25
    v_add_u32 v30, s73, v30
    v_xor_b32 v24, v24, v29
    v_lshlrev_b32 v24, 4, v24
    v_lshl_add_u32 v24, v28, 7, v24
    v_add_u32 v2, s39, v24
    v_xor_b32 v3, 32, v2
    v_xor_b32 v4, 64, v2
    v_xor_b32 v5, 96, v2
    s_mul_i32 s28, s16, 2560
    s_add_u32 s28, s28, 32768
    v_mul_u32_u24 v24, 80, v28
    v_add_u32 v24, s28, v24
    v_lshl_add_u32 v10, v29, 5, v24
    v_lshl_add_u32 v12, v29, 4, v24
    v_bfe_u32 v24, v1, 2, 2
    v_and_b32 v25, 3, v1
    v_and_b32 v26, 1, v20
    v_lshlrev_b32 v25, 3, v25
    v_lshl_add_u32 v25, v26, 5, v25
    v_lshl_add_u32 v27, v29, 2, v24
    v_mul_u32_u24 v27, 80, v27
    v_add_u32 v27, v27, v25
    v_add_u32 v13, s28, v27
    v_mov_b32 v26, 136
    v_mov_b32 v27, 128
    v_cndmask_b32 v27, v26, v27, s[30:31]
    v_mad_u32_u24 v24, v24, v27, v25
    v_mov_b32 v26, 85760
    v_mov_b32 v27, 116224
    v_cndmask_b32 v26, v26, v27, s[30:31]
    v_add_u32 v14, v24, v26
    v_mov_b32 v26, 136
    v_mov_b32 v19, 0
    v_cndmask_b32 v15, v26, v19, s[30:31]
    v_and_b32 v24, 7, v28
    v_cmp_eq_u32 vcc, 0, v24
    v_mul_u32_u24 v25, 136, v24
    v_lshl_add_u32 v25, v29, 3, v25
    v_mov_b32 v26, 117312
    v_mov_b32 v27, 85760
    v_cndmask_b32 v26, v26, v27, vcc
    v_add_u32 v16, v26, v25
    v_lshrrev_b32 v25, 3, v28
    v_lshlrev_b32 v25, 2, v25
    v_lshl_add_u32 v25, v24, 4, v25
    v_mov_b32 v26, 145056
    v_mov_b32 v27, 148320
    v_cndmask_b32 v26, v26, v27, vcc
    v_add_u32 v17, v26, v25
    v_mov_b32 v248, 1
    v_mov_b32 v220, 0
    v_mov_b32 v88, 0
    v_mov_b32 v89, 0
    v_mov_b32 v90, 0
    v_mov_b32 v91, 0
    v_mov_b32 v92, 0
    v_mov_b32 v93, 0
    v_mov_b32 v94, 0
    v_mov_b32 v95, 0
    v_mov_b32 v96, 0
    v_mov_b32 v97, 0
    v_mov_b32 v98, 0
    v_mov_b32 v99, 0
    v_mov_b32 v100, 0
    v_mov_b32 v101, 0
    v_mov_b32 v102, 0
    v_mov_b32 v103, 0
    s_add_u32 s39, s16, 0
    s_min_u32 s22, s39, 4
    s_sub_u32 s39, s39, s22
    s_mul_i32 s22, s22, 40
    s_mul_i32 s39, s39, 24
    s_add_u32 s22, s22, s39
    s_add_u32 s39, s16, 1
    s_min_u32 s27, s39, 4
    s_sub_u32 s39, s39, s27
    s_mul_i32 s27, s27, 40
    s_mul_i32 s39, s39, 24
    s_add_u32 s27, s27, s39
    s_lshl_b32 s28, s16, 5
    v_lshrrev_b32 v24, 3, v1
    v_add_u32 v24, s28, v24
    s_mov_b32 s29, 27264
    v_mul_lo_u32 v24, v24, s29
    v_and_b32 v25, 7, v1
    v_lshl_add_u32 v24, v25, 4, v24
    v_lshlrev_b32 v25, 1, v25
    v_add_u32 v225, 1, v25
    v_add_u32 v228, 32, v25
    v_add_u32 v229, 33, v25
    v_mov_b32 v224, v25
    v_bfe_u32 v26, v1, 2, 1
    v_lshrrev_b32 v25, 3, v1
    v_lshl_add_u32 v26, v26, 3, v25
    v_add_u32 v26, s28, v26
    v_mul_lo_u32 v26, v26, s29
    s_mov_b32 s34, 0xf0f0f0f0
    s_mov_b32 s35, 0xf0f0f0f0
    v_and_b32 v25, 3, v1
    v_lshl_add_u32 v26, v25, 4, v26
    v_lshlrev_b32 v25, 1, v25
    v_add_u32 v226, 16, v25
    v_add_u32 v227, 17, v25
    v_mov_b32 v193, 2080
    ds_read_b64 v[194:195], v193
    v_lshrrev_b32 v192, 3, v1
    s_lshl_b32 s28, s16, 5
    v_add_u32 v192, s28, v192
    v_mul_u32_u24 v192, 2176, v192
    s_lshl_b32 s20, s98, 3
    s_add_u32 s20, s20, 7340032
    s_add_u32 s21, s20, 17408
    s_add_u32 s23, s20, 34816
    s_add_u32 s19, s20, 52224
    buffer_load_dwordx2 v[184:185], v192, s[8:11], s20 offen offset:0 sc1
    buffer_load_dwordx2 v[186:187], v192, s[8:11], s21 offen offset:0 sc1
    buffer_load_dwordx2 v[188:189], v192, s[8:11], s23 offen offset:0 sc1
    buffer_load_dwordx2 v[190:191], v192, s[8:11], s19 offen offset:0 sc1
    s_waitcnt lgkmcnt(0)
    v_readfirstlane_b32 s74, v194
    v_readfirstlane_b32 s75, v195
    s_mov_b32 s78, 200000
    s_mov_b32 s79, 0xf000f000
    s_nop 1
    s_lshl_b32 s24, s74, 16
    s_lshr_b32 s25, s74, 7
    s_and_b32 s25, s25, 0xfe00
    s_mul_i32 s17, s74, 0x9e3779b1
    s_add_u32 s17, s17, s75
    s_and_b32 s26, s17, 0xffff0000
    s_and_b32 s17, s17, 0xfe00
    v_mov_b32 v116, s24
    v_mov_b32 v117, s25
    v_mov_b32 v118, s26
    v_mov_b32 v119, s17
    v_mov_b32 v120, s24
    v_mov_b32 v121, s25
    v_mov_b32 v122, s26
    v_mov_b32 v123, s17
    v_mov_b32 v124, s24
    v_mov_b32 v125, s25
    v_mov_b32 v126, s26
    v_mov_b32 v127, s17
    v_mov_b32 v128, s24
    v_mov_b32 v129, s25
    v_mov_b32 v130, s26
    v_mov_b32 v131, s17
    v_mov_b32 v132, s24
    v_mov_b32 v133, s25
    v_mov_b32 v134, s26
    v_mov_b32 v135, s17
    v_mov_b32 v136, s24
    v_mov_b32 v137, s25
    v_mov_b32 v138, s26
    v_mov_b32 v139, s17
KM_poll:
    s_waitcnt vmcnt(0)
KM_pchk:
    v_and_b32 v196, s79, v184
    v_xor_b32 v196, s75, v196
    v_xor_b32 v197, s74, v185
    v_or_b32 v196, v196, v197
    v_cmp_ne_u32 s[40:41], 0, v196
    v_and_b32 v196, s79, v186
    v_xor_b32 v196, s75, v196
    v_xor_b32 v197, s74, v187
    v_or_b32 v196, v196, v197
    v_cmp_ne_u32 s[42:43], 0, v196
    v_and_b32 v196, s79, v188
    v_xor_b32 v196, s75, v196
    v_xor_b32 v197, s74, v189
    v_or_b32 v196, v196, v197
    v_cmp_ne_u32 s[44:45], 0, v196
    v_and_b32 v196, s79, v190
    v_xor_b32 v196, s75, v196
    v_xor_b32 v197, s74, v191
    v_or_b32 v196, v196, v197
    v_cmp_ne_u32 s[46:47], 0, v196
    s_or_b64 s[76:77], s[40:41], s[42:43]
    s_or_b64 s[76:77], s[76:77], s[44:45]
    s_or_b64 s[76:77], s[76:77], s[46:47]
    s_cbranch_scc0 KM_got
    s_sub_u32 s78, s78, 1
    s_cbranch_scc1 KM_got
    s_mov_b64 exec, s[40:41]
    buffer_load_dwordx2 v[184:185], v192, s[8:11], s20 offen offset:0 sc1
    s_mov_b64 exec, s[42:43]
    buffer_load_dwordx2 v[186:187], v192, s[8:11], s21 offen offset:0 sc1
    s_mov_b64 exec, s[44:45]
    buffer_load_dwordx2 v[188:189], v192, s[8:11], s23 offen offset:0 sc1
    s_mov_b64 exec, s[46:47]
    buffer_load_dwordx2 v[190:191], v192, s[8:11], s19 offen offset:0 sc1
    s_mov_b64 exec, -1
    s_branch KM_poll
KM_got:
    s_mov_b32 s79, 0x0fff0fff
    v_and_b32 v180, s79, v184
    v_and_b32 v181, s79, v186
    v_and_b32 v182, s79, v188
    v_and_b32 v183, s79, v190
    v_mov_b32 v188, 0xffff
    s_add_u32 s29, s72, 7102464
    s_add_u32 m0, s72, 4096
    s_nop 0
    buffer_load_dwordx4 v31, s[8:11], s29 offen lds
    s_add_u32 s29, s72, 7094272
    s_add_u32 m0, s72, 12288
    s_nop 0
    buffer_load_dwordx4 v31, s[8:11], s29 offen lds
    v_lshlrev_b32_sdwa v22, 3, v180 dst_sel:DWORD dst_unused:UNUSED_PAD src0_sel:DWORD src1_sel:WORD_0
    v_add_u32 v22, v22, v24
    s_mov_b32 s29, 0
    v_cmp_gt_u32_sdwa s[40:41], v180, v224 src0_sel:WORD_1 src1_sel:DWORD
    v_cmp_gt_u32_sdwa s[42:43], v180, v225 src0_sel:WORD_1 src1_sel:DWORD
    s_mov_b64 exec, s[40:41]
    buffer_load_dwordx4 v[116:119], v22, s[8:11], s29 offen offset:0
    s_mov_b64 exec, -1
    v_lshlrev_b32_sdwa v22, 3, v181 dst_sel:DWORD dst_unused:UNUSED_PAD src0_sel:DWORD src1_sel:WORD_0
    v_add_u32 v22, v22, v24
    s_mov_b32 s29, 218112
    v_cmp_gt_u32_sdwa s[44:45], v181, v224 src0_sel:WORD_1 src1_sel:DWORD
    v_cmp_gt_u32_sdwa s[46:47], v181, v225 src0_sel:WORD_1 src1_sel:DWORD
    s_mov_b64 exec, s[44:45]
    buffer_load_dwordx4 v[120:123], v22, s[8:11], s29 offen offset:0
    s_mov_b64 exec, -1
    v_lshlrev_b32_sdwa v22, 3, v182 dst_sel:DWORD dst_unused:UNUSED_PAD src0_sel:DWORD src1_sel:WORD_0
    v_add_u32 v22, v22, v24
    s_mov_b32 s29, 436224
    v_cmp_gt_u32_sdwa s[48:49], v182, v224 src0_sel:WORD_1 src1_sel:DWORD
    v_cmp_gt_u32_sdwa s[50:51], v182, v225 src0_sel:WORD_1 src1_sel:DWORD
    s_mov_b64 exec, s[48:49]
    buffer_load_dwordx4 v[124:127], v22, s[8:11], s29 offen offset:0
    s_mov_b64 exec, -1
    v_lshlrev_b32_sdwa v22, 3, v183 dst_sel:DWORD dst_unused:UNUSED_PAD src0_sel:DWORD src1_sel:WORD_0
    v_add_u32 v22, v22, v24
    s_mov_b32 s29, 654336
    v_cmp_gt_u32_sdwa s[52:53], v183, v224 src0_sel:WORD_1 src1_sel:DWORD
    v_cmp_gt_u32_sdwa s[54:55], v183, v225 src0_sel:WORD_1 src1_sel:DWORD
    s_mov_b64 exec, s[52:53]
    buffer_load_dwordx4 v[128:131], v22, s[8:11], s29 offen offset:0
    s_mov_b64 exec, -1
    v_cndmask_b32 v184, v180, v181, s[34:35]
    v_lshlrev_b32_sdwa v22, 3, v184 dst_sel:DWORD dst_unused:UNUSED_PAD src0_sel:DWORD src1_sel:WORD_0
    v_add_u32 v22, v22, v26
    s_mov_b32 s29, 0
    v_cmp_gt_u32_sdwa s[56:57], v184, v226 src0_sel:WORD_1 src1_sel:DWORD
    v_cmp_gt_u32_sdwa s[58:59], v184, v227 src0_sel:WORD_1 src1_sel:DWORD
    s_mov_b64 exec, s[56:57]
    buffer_load_dwordx4 v[132:135], v22, s[8:11], s29 offen offset:128
    s_mov_b64 exec, -1
    v_cndmask_b32 v185, v182, v183, s[34:35]
    v_lshlrev_b32_sdwa v22, 3, v185 dst_sel:DWORD dst_unused:UNUSED_PAD src0_sel:DWORD src1_sel:WORD_0
    v_add_u32 v22, v22, v26
    s_mov_b32 s29, 436224
    v_cmp_gt_u32_sdwa s[60:61], v185, v226 src0_sel:WORD_1 src1_sel:DWORD
    v_cmp_gt_u32_sdwa s[62:63], v185, v227 src0_sel:WORD_1 src1_sel:DWORD
    s_mov_b64 exec, s[60:61]
    buffer_load_dwordx4 v[136:139], v22, s[8:11], s29 offen offset:128
    s_mov_b64 exec, -1
    v_max_u32 v27, v180, v181
    v_max_u32 v27, v27, v182
    v_max_u32 v27, v27, v183
    s_mov_b32 s28, 1638400
    s_mov_b32 s18, 0
    s_mov_b32 s99, 0
    v_cmp_le_u32 vcc, s28, v27
    s_cbranch_vccnz K2_rare_1o
K2_rare_1:
    s_add_u32 s29, s72, 7127040
    s_add_u32 m0, s72, 151584
    s_nop 0
    buffer_load_dwordx4 v31, s[8:11], s29 offen lds
    s_cmp_eq_u32 s16, 7
    s_cselect_b64 exec, -1, 0
    s_mov_b32 s29, 7114752
    s_mov_b32 m0, 116224
    s_nop 0
    buffer_load_dwordx4 v31, s[8:11], s29 offen lds
    s_mov_b64 exec, -1
    s_cmp_eq_u32 s18, 0
    s_cbranch_scc0 K2_wa0
    s_waitcnt vmcnt(8) lgkmcnt(0)
K2_wa1:
    s_barrier
    s_mov_b32 s76, s32
    s_or_b32 s77, s33, 393216
    s_mov_b32 s78, 50000
    s_mov_b32 s79, 0x20000
    v_add_u32 v22, s38, v0
    buffer_load_dwordx2 v[214:215], v22, s[76:79], 0 idxen
    v_lshlrev_b32 v22, 6, v29
    s_mov_b32 s29, 7110656
    buffer_load_dwordx4 v[64:67], v22, s[8:11], s29 offen offset:0
    buffer_load_dwordx4 v[68:71], v22, s[8:11], s29 offen offset:16
    buffer_load_dwordx4 v[72:75], v22, s[8:11], s29 offen offset:32
    buffer_load_dwordx4 v[76:79], v22, s[8:11], s29 offen offset:48
    s_mov_b32 m0, s73
    s_nop 0
    s_cmp_lt_u32 s16, 7
    s_cselect_b64 exec, -1, 0
    buffer_load_dwordx4 v[250:251], s[4:7], 0 idxen offen offset:0 lds
    buffer_load_dwordx4 v[252:253], s[4:7], 0 idxen offen offset:1024 lds
    s_cmp_lt_u32 s16, 6
    s_cselect_b64 exec, -1, 0
    buffer_load_dwordx4 v[254:255], s[4:7], 0 idxen offen offset:2048 lds
    buffer_load_dwordx4 v[6:7], s[4:7], 0 idxen offen offset:3072 lds
    s_mov_b64 exec, -1
    ds_read_b128 v[32:35], v31 offset:12288
    ds_read_b128 v[36:39], v31 offset:13312
    ds_read_b128 v[40:43], v31 offset:14336
    ds_read_b128 v[44:47], v31 offset:15360
    ds_read_b128 v[48:51], v31 offset:16384
    ds_read_b128 v[52:55], v31 offset:17408
    ds_read_b128 v[56:59], v31 offset:18432
    ds_read_b128 v[60:63], v31 offset:19456
    ds_read_b128 v[196:199], v31 offset:4096
    ds_read_b128 v[200:203], v31 offset:5120
    ds_read_b128 v[204:207], v31 offset:6144
    ds_read_b128 v[208:211], v31 offset:7168
    ds_read_b128 v[164:167], v31 offset:8192
    ds_read_b128 v[168:171], v31 offset:9216
    ds_read_b128 v[172:175], v31 offset:10240
    ds_read_b128 v[176:179], v31 offset:11264
    s_cmp_eq_u32 s99, 2
    s_cbranch_scc0 K2_nobad2
    ds_write_b32 v19, v248 offset:2048
K2_nobad2:
    s_waitcnt vmcnt(11)
    s_mov_b32 s78, 200000
K2_chk:
    v_xor_b32 v116, s24, v116
    v_xor_b32 v117, s25, v117
    v_xor_b32 v118, s26, v118
    v_xor_b32 v119, s17, v119
    v_or_b32 v189, v116, v118
    v_or_b32 v190, v117, v119
    v_xor_b32 v120, s24, v120
    v_xor_b32 v121, s25, v121
    v_xor_b32 v122, s26, v122
    v_xor_b32 v123, s17, v123
    v_or3_b32 v189, v120, v122, v189
    v_or3_b32 v190, v121, v123, v190
    v_xor_b32 v124, s24, v124
    v_xor_b32 v125, s25, v125
    v_xor_b32 v126, s26, v126
    v_xor_b32 v127, s17, v127
    v_or3_b32 v189, v124, v126, v189
    v_or3_b32 v190, v125, v127, v190
    v_xor_b32 v128, s24, v128
    v_xor_b32 v129, s25, v129
    v_xor_b32 v130, s26, v130
    v_xor_b32 v131, s17, v131
    v_or3_b32 v189, v128, v130, v189
    v_or3_b32 v190, v129, v131, v190
    v_xor_b32 v132, s24, v132
    v_xor_b32 v133, s25, v133
    v_xor_b32 v134, s26, v134
    v_xor_b32 v135, s17, v135
    v_or3_b32 v189, v132, v134, v189
    v_or3_b32 v190, v133, v135, v190
    v_xor_b32 v136, s24, v136
    v_xor_b32 v137, s25, v137
    v_xor_b32 v138, s26, v138
    v_xor_b32 v139, s17, v139
    v_or3_b32 v189, v136, v138, v189
    v_or3_b32 v190, v137, v139, v190
    v_bfi_b32 v189, v188, v190, v189
    v_cmp_lt_u32 vcc, 0x1ff, v189
    s_cbranch_vccnz K2_rare_2o
K2_rare_2:
K2_chkx:
    s_cmp_eq_u32 s18, 0
    s_cbranch_scc0 K2_rare_3o
K2_rare_3:
    s_mov_b64 exec, s[40:41]
    v_lshlrev_b32_sdwa v88, 1, v117 dst_sel:DWORD dst_unused:UNUSED_PAD src0_sel:DWORD src1_sel:WORD_0
    ds_add_rtn_u32 v148, v88, v248
    s_mov_b64 exec, s[42:43]
    v_lshlrev_b32_sdwa v89, 1, v119 dst_sel:DWORD dst_unused:UNUSED_PAD src0_sel:DWORD src1_sel:WORD_0
    ds_add_rtn_u32 v149, v89, v248
    s_mov_b64 exec, s[44:45]
    v_lshlrev_b32_sdwa v90, 1, v121 dst_sel:DWORD dst_unused:UNUSED_PAD src0_sel:DWORD src1_sel:WORD_0
    ds_add_rtn_u32 v150, v90, v248
    s_mov_b64 exec, s[46:47]
    v_lshlrev_b32_sdwa v91, 1, v123 dst_sel:DWORD dst_unused:UNUSED_PAD src0_sel:DWORD src1_sel:WORD_0
    ds_add_rtn_u32 v151, v91, v248
    s_mov_b64 exec, s[48:49]
    v_lshlrev_b32_sdwa v92, 1, v125 dst_sel:DWORD dst_unused:UNUSED_PAD src0_sel:DWORD src1_sel:WORD_0
    ds_add_rtn_u32 v152, v92, v248
    s_mov_b64 exec, s[50:51]
    v_lshlrev_b32_sdwa v93, 1, v127 dst_sel:DWORD dst_unused:UNUSED_PAD src0_sel:DWORD src1_sel:WORD_0
    ds_add_rtn_u32 v153, v93, v248
    s_mov_b64 exec, s[52:53]
    v_lshlrev_b32_sdwa v94, 1, v129 dst_sel:DWORD dst_unused:UNUSED_PAD src0_sel:DWORD src1_sel:WORD_0
    ds_add_rtn_u32 v154, v94, v248
    s_mov_b64 exec, s[54:55]
    v_lshlrev_b32_sdwa v95, 1, v131 dst_sel:DWORD dst_unused:UNUSED_PAD src0_sel:DWORD src1_sel:WORD_0
    ds_add_rtn_u32 v155, v95, v248
    s_mov_b64 exec, s[56:57]
    v_lshlrev_b32_sdwa v96, 1, v133 dst_sel:DWORD dst_unused:UNUSED_PAD src0_sel:DWORD src1_sel:WORD_0
    ds_add_rtn_u32 v156, v96, v248
    s_mov_b64 exec, s[58:59]
    v_lshlrev_b32_sdwa v97, 1, v135 dst_sel:DWORD dst_unused:UNUSED_PAD src0_sel:DWORD src1_sel:WORD_0
    ds_add_rtn_u32 v157, v97, v248
    s_mov_b64 exec, s[60:61]
    v_lshlrev_b32_sdwa v98, 1, v137 dst_sel:DWORD dst_unused:UNUSED_PAD src0_sel:DWORD src1_sel:WORD_0
    ds_add_rtn_u32 v158, v98, v248
    s_mov_b64 exec, s[62:63]
    v_lshlrev_b32_sdwa v99, 1, v139 dst_sel:DWORD dst_unused:UNUSED_PAD src0_sel:DWORD src1_sel:WORD_0
    ds_add_rtn_u32 v159, v99, v248
    s_mov_b64 exec, -1
    s_cmp_eq_u32 s18, 0
    s_cbranch_scc0 K2_rare_4o
K2_rare_4:
    s_cmp_eq_u32 s99, 0
    s_cbranch_scc0 K2_rare_5o
K2_rare_5:
    s_cmp_eq_u32 s99, 0
    s_cbranch_scc0 K2_rare_6o
K2_rare_6:
    s_waitcnt vmcnt(4)
    v_cmp_gt_u32 vcc, 224, v0
    s_and_saveexec_b64 s[34:35], vcc
    v_lshlrev_b32 v22, 4, v0
    v_lshlrev_b32 v24, 16, v214
    v_and_b32 v25, 0xffff0000, v214
    v_lshlrev_b32 v26, 16, v215
    ds_write_b96 v22, v[24:26] offset:53248
    s_mov_b64 exec, s[34:35]
    s_waitcnt lgkmcnt(0)
    s_barrier
    v_lshlrev_b32 v22, 4, v1
    ds_read_b128 v[24:27], v22
    ds_read_b32 v23, v19 offset:2048
    s_waitcnt lgkmcnt(0)
    v_max_u32 v225, v24, v25
    v_max_u32 v226, v26, v27
    v_max_u32 v225, v225, v226
    v_add_u32 v25, v24, v25
    v_add_u32 v26, v25, v26
    v_add_u32 v27, v26, v27
    v_mov_b32 v227, v27
    s_nop 1
    v_add_u32_dpp v227, v227, v227 row_shr:1 row_mask:0xf bank_mask:0xf bound_ctrl:0
    s_nop 1
    v_add_u32_dpp v227, v227, v227 row_shr:2 row_mask:0xf bank_mask:0xf bound_ctrl:0
    s_nop 1
    v_add_u32_dpp v227, v227, v227 row_shr:4 row_mask:0xf bank_mask:0xf bound_ctrl:0
    s_nop 1
    v_add_u32_dpp v227, v227, v227 row_shr:8 row_mask:0xf bank_mask:0xf bound_ctrl:0
    s_nop 1
    v_add_u32_dpp v227, v227, v227 row_bcast:15 row_mask:0xa bank_mask:0xf
    s_nop 1
    v_add_u32_dpp v227, v227, v227 row_bcast:31 row_mask:0xc bank_mask:0xf
    v_sub_u32 v180, v227, v27
    v_add_u32 v181, v180, v24
    v_add_u32 v182, v180, v25
    v_add_u32 v183, v180, v26
    ds_write_b128 v22, v[180:183] offset:1024
    v_readlane_b32 s17, v227, 63
    v_readfirstlane_b32 s28, v23
    s_movk_i32 s29, 1408
    v_cmp_lt_u32 vcc, s29, v225
    s_cmp_lg_u32 s28, 0
    s_cbranch_scc1 K2_slow
    s_cmp_gt_u32 s17, 3584
    s_cbranch_scc1 K2_slow
    s_cbranch_vccnz K2_slow
    ds_read_b32 v88, v88 offset:1024
    ds_read_b32 v89, v89 offset:1024
    ds_read_b32 v90, v90 offset:1024
    ds_read_b32 v91, v91 offset:1024
    ds_read_b32 v92, v92 offset:1024
    ds_read_b32 v93, v93 offset:1024
    ds_read_b32 v94, v94 offset:1024
    ds_read_b32 v95, v95 offset:1024
    ds_read_b32 v96, v96 offset:1024
    ds_read_b32 v97, v97 offset:1024
    ds_read_b32 v98, v98 offset:1024
    ds_read_b32 v99, v99 offset:1024
    s_cmp_eq_u32 s18, 0
    s_cbranch_scc0 K2_rare_7o
K2_rare_7:
    s_cmp_eq_u32 s99, 0
    s_cbranch_scc0 K2_rare_8o
K2_rare_8:
    s_lshr_b32 s28, s37, 2
    s_bfm_b64 s[74:75], s28, 0
    v_cmp_gt_u32 vcc, 31, v27
    s_add_u32 s19, s17, 31
    s_lshr_b32 s19, s19, 5
    s_and_b64 vcc, vcc, s[74:75]
    s_cbranch_scc1 K2_oldmode
    s_and_b32 s20, s19, 3
    s_lshr_b32 s19, s19, 2
    s_mul_i32 s21, s19, 86
    s_add_u32 s23, s21, 86
    s_add_u32 s21, s21, 0
    s_lshr_b32 s21, s21, 8
    s_lshr_b32 s23, s23, 8
    s_sub_u32 s25, s19, s21
    s_sub_u32 s26, s19, s23
    s_add_u32 s26, s26, 1
    s_sub_u32 s28, s26, s25
    s_mul_i32 s28, s28, s20
    s_lshl2_add_u32 s28, s25, s28
    s_and_b32 s24, s16, 3
    s_cmp_ge_u32 s16, 4
    s_cselect_b32 s25, s21, s25
    s_cselect_b32 s26, s23, s26
    s_cselect_b32 s28, s28, 0
    s_mul_i32 s21, s25, s24
    s_add_u32 s28, s28, s21
    s_add_u32 s21, s24, s20
    s_max_u32 s21, s21, 4
    s_sub_u32 s21, s21, 4
    s_sub_u32 s23, s26, s25
    s_mul_i32 s21, s21, s23
    s_add_u32 s28, s28, s21
    s_add_u32 s21, s24, s20
    s_cmp_ge_u32 s21, 4
    s_cselect_b32 s25, s26, s25
    s_add_u32 s25, s25, s28
    s_lshl_b32 s28, s28, 5
    s_lshl_b32 s29, s25, 5
    s_min_u32 s79, s28, s17
    s_min_u32 s3, s29, s17
    v_cmp_lt_u32 vcc, 32, v225
    s_cbranch_vccnz K2_rare_9o
K2_rare_9:
    v_cmp_gt_u32 vcc, s3, v180
    v_cmp_gt_u32 s[74:75], s3, v181
    v_cmp_gt_u32 s[34:35], s3, v182
    v_cmp_gt_u32 s[76:77], s3, v183
    s_bcnt1_i32_b64 s78, vcc
    s_bcnt1_i32_b64 s39, s[74:75]
    s_bcnt1_i32_b64 s74, s[34:35]
    s_bcnt1_i32_b64 s75, s[76:77]
    s_add_u32 s78, s78, s39
    s_add_u32 s74, s74, s75
    s_add_u32 s78, s78, s74
K2_ranges:
    s_waitcnt lgkmcnt(0)
    s_mov_b64 exec, s[40:41]
    v_add_lshl_u32 v88, v88, v148, 3
    ds_write_b64 v88, v[116:117] offset:56832
    s_mov_b64 exec, s[42:43]
    v_add_lshl_u32 v89, v89, v149, 3
    ds_write_b64 v89, v[118:119] offset:56832
    s_mov_b64 exec, s[44:45]
    v_add_lshl_u32 v90, v90, v150, 3
    ds_write_b64 v90, v[120:121] offset:56832
    s_mov_b64 exec, s[46:47]
    v_add_lshl_u32 v91, v91, v151, 3
    ds_write_b64 v91, v[122:123] offset:56832
    s_mov_b64 exec, s[48:49]
    v_add_lshl_u32 v92, v92, v152, 3
    ds_write_b64 v92, v[124:125] offset:56832
    s_mov_b64 exec, s[50:51]
    v_add_lshl_u32 v93, v93, v153, 3
    ds_write_b64 v93, v[126:127] offset:56832
    s_mov_b64 exec, s[52:53]
    v_add_lshl_u32 v94, v94, v154, 3
    ds_write_b64 v94, v[128:129] offset:56832
    s_mov_b64 exec, s[54:55]
    v_add_lshl_u32 v95, v95, v155, 3
    ds_write_b64 v95, v[130:131] offset:56832
    s_mov_b64 exec, s[56:57]
    v_add_lshl_u32 v96, v96, v156, 3
    ds_write_b64 v96, v[132:133] offset:56832
    s_mov_b64 exec, s[58:59]
    v_add_lshl_u32 v97, v97, v157, 3
    ds_write_b64 v97, v[134:135] offset:56832
    s_mov_b64 exec, s[60:61]
    v_add_lshl_u32 v98, v98, v158, 3
    ds_write_b64 v98, v[136:137] offset:56832
    s_mov_b64 exec, s[62:63]
    v_add_lshl_u32 v99, v99, v159, 3
    ds_write_b64 v99, v[138:139] offset:56832
    s_mov_b64 exec, -1
    s_cmp_eq_u32 s18, 0
    s_cbranch_scc0 K2_rare_10o
K2_rare_10:
    s_cmp_eq_u32 s99, 0
    s_cbranch_scc0 K2_rare_11o
K2_rare_11:
    s_sub_u32 s28, s3, s79
    s_add_u32 s19, s28, 31
    s_lshr_b32 s19, s19, 5
    s_sub_u32 s39, s3, 1
    s_max_i32 s39, s39, 0
    v_lshl_add_u32 v22, v1, 5, s79
    v_add_u32 v23, 31, v22
    v_min_u32 v22, s39, v22
    v_min_u32 v23, s39, v23
    v_lshlrev_b32 v22, 3, v22
    v_lshlrev_b32 v23, 3, v23
    s_lshl_b32 s28, s79, 3
    s_add_u32 s28, s28, 56832
    v_lshrrev_b32 v25, 3, v1
    v_lshlrev_b32 v25, 3, v25
    v_add_u32 v8, s28, v25
    v_lshlrev_b32 v25, 3, v1
    v_add_u32 v9, s28, v25
    s_mov_b32 s20, 0
    s_mov_b32 s52, s32
    s_or_b32 s53, s33, 393216
    s_mov_b32 s54, 50000
    s_mov_b32 s55, 0x20000
    s_lshl_b32 m0, s16, 12
    s_mov_b32 s45, 0xffff
    s_mov_b32 s56, 0x01010101
    s_mov_b32 s57, 0x01010101
    s_mul_i32 s59, s16, 136
    s_add_u32 s59, s59, 159776
    s_sub_u32 s58, s59, 85760
    s_mov_b32 s60, 0
    s_sub_u32 s42, s3, s79
    s_mov_b32 s43, 0
    s_mov_b64 s[76:77], 0
    v_mov_b32 v27, 1.0
    v_mov_b32 v248, 0x3f003f00
    v_mov_b32 v249, 0
    s_waitcnt lgkmcnt(0)
    s_barrier
    ds_read_u16 v22, v22 offset:56836
    ds_read_u16 v23, v23 offset:56836
    ds_read_b32 v250, v8 offset:0
    ds_read_b32 v252, v8 offset:64
    ds_read_b32 v254, v8 offset:128
    ds_read_b32 v6, v8 offset:192
    v_add_u32 v8, 256, v8
    ds_read_b64 v[212:213], v9
    v_add_u32 v9, 512, v9
    s_cmp_ge_u32 s16, 4
    s_cbranch_scc1 K2_y1
    s_waitcnt lgkmcnt(0)
    buffer_load_dwordx4 v[250:251], s[4:7], 0 idxen offen offset:0 lds
    buffer_load_dwordx4 v[252:253], s[4:7], 0 idxen offen offset:1024 lds
    buffer_load_dwordx4 v[254:255], s[4:7], 0 idxen offen offset:2048 lds
    buffer_load_dwordx4 v[6:7], s[4:7], 0 idxen offen offset:3072 lds
    buffer_load_dwordx2 v[214:215], v212, s[52:55], 0 idxen
    v_lshlrev_b32_sdwa v231, 3, v213 dst_sel:DWORD dst_unused:UNUSED_PAD src0_sel:DWORD src1_sel:WORD_0
    ds_read_b96 v[228:230], v231 offset:53248
    v_lshl_or_b32 v18, v23, 16, v22
    v_sub_u32 v24, v23, v22
    s_max_u32 s28, s19, 1
    s_sub_u32 s28, s28, 1
    v_readlane_b32 s44, v18, s28
    v_readlane_b32 s21, v18, 0
    s_lshr_b32 s44, s44, 16
    s_sub_u32 s29, s19, 3
    s_or_b32 s29, s29, 1
    s_sub_u32 s39, s3, s79
    s_and_b32 s39, s39, 31
    s_cmp_eq_u32 s39, 0
    s_cselect_b32 s29, s28, s29
    v_cmp_eq_u32 vcc, s28, v1
    v_cmp_eq_u32 s[74:75], s29, v1
    s_or_b64 vcc, vcc, s[74:75]
    v_or_b32 v25, 0x80000000, v18
    v_cndmask_b32 v18, v18, v25, vcc
    s_and_b32 s24, s21, 0xffff
    s_add_u32 s41, s24, 16
    s_mov_b32 s40, s24
    s_branch K2_at
K2_y1:
    s_waitcnt vmcnt(0)
K2_at:
    s_cmp_eq_u32 s16, 7
    s_cbranch_scc1 K2_noard_12
    s_waitcnt vmcnt(5)
    v_xor_b32 v224, 0, v30
    ds_read_b64 v[232:233], v224
    v_xor_b32 v224, 16, v30
    ds_read_b64 v[234:235], v224
    v_xor_b32 v224, 32, v30
    ds_read_b64 v[236:237], v224
    v_xor_b32 v224, 48, v30
    ds_read_b64 v[238:239], v224
    v_xor_b32 v224, 64, v30
    ds_read_b64 v[240:241], v224
    v_xor_b32 v224, 80, v30
    ds_read_b64 v[242:243], v224
    v_xor_b32 v224, 96, v30
    ds_read_b64 v[244:245], v224
    v_xor_b32 v224, 112, v30
    ds_read_b64 v[246:247], v224
K2_noard_12:
    s_cmp_eq_u32 s16, 7
    s_cbranch_scc1 K2_noatab_13
    s_mov_b32 s28, 3216550459
    s_mov_b32 s29, 3216550459
    v_mul_u32_u24 v225, 136, v28
    v_lshl_add_u32 v225, v29, 3, v225
    v_add_u32 v225, s73, v225
    s_waitcnt lgkmcnt(0)
    v_mfma_f32_32x32x16_bf16 v[88:103], v[196:199], v[232:235], 0
    v_mfma_f32_32x32x16_bf16 v[88:103], v[200:203], v[236:239], v[88:103]
    v_mfma_f32_32x32x16_bf16 v[88:103], v[204:207], v[240:243], v[88:103]
    v_mfma_f32_32x32x16_bf16 v[88:103], v[208:211], v[244:247], v[88:103]
    v_mfma_f32_32x32x16_bf16 v[116:131], v[164:167], v[232:235], 0
    v_mfma_f32_32x32x16_bf16 v[116:131], v[168:171], v[236:239], v[116:131]
    v_mfma_f32_32x32x16_bf16 v[116:131], v[172:175], v[240:243], v[116:131]
    v_mfma_f32_32x32x16_bf16 v[116:131], v[176:179], v[244:247], v[116:131]
    s_nop 7
    s_nop 3
    v_cvt_pk_bf16_f32 v88, v88, v89
    v_cvt_pk_bf16_f32 v89, v90, v91
    v_cvt_pk_bf16_f32 v90, v92, v93
    v_cvt_pk_bf16_f32 v91, v94, v95
    v_cvt_pk_bf16_f32 v92, v96, v97
    v_cvt_pk_bf16_f32 v93, v98, v99
    v_cvt_pk_bf16_f32 v94, v100, v101
    v_cvt_pk_bf16_f32 v95, v102, v103
    ds_write2_b64 v225, v[88:89], v[90:91] offset0:0 offset1:2
    ds_write2_b64 v225, v[92:93], v[94:95] offset0:4 offset1:6
    v_cvt_pk_bf16_f32 v116, v116, v117
    v_cvt_pk_bf16_f32 v117, v118, v119
    v_cvt_pk_bf16_f32 v118, v120, v121
    v_cvt_pk_bf16_f32 v119, v122, v123
    v_cvt_pk_bf16_f32 v120, v124, v125
    v_cvt_pk_bf16_f32 v121, v126, v127
    v_cvt_pk_bf16_f32 v122, v128, v129
    v_cvt_pk_bf16_f32 v123, v130, v131
    ds_write2_b64 v225, v[116:117], v[118:119] offset0:8 offset1:10
    ds_write2_b64 v225, v[120:121], v[122:123] offset0:12 offset1:14
K2_noatab_13:
    s_waitcnt lgkmcnt(0)
    s_barrier
    s_cmp_lt_u32 s16, 4
    s_cbranch_scc1 K2_o2
    s_waitcnt lgkmcnt(0)
    buffer_load_dwordx4 v[250:251], s[4:7], 0 idxen offen offset:0 lds
    buffer_load_dwordx4 v[252:253], s[4:7], 0 idxen offen offset:1024 lds
    buffer_load_dwordx4 v[254:255], s[4:7], 0 idxen offen offset:2048 lds
    buffer_load_dwordx4 v[6:7], s[4:7], 0 idxen offen offset:3072 lds
    buffer_load_dwordx2 v[214:215], v212, s[52:55], 0 idxen
    v_lshlrev_b32_sdwa v231, 3, v213 dst_sel:DWORD dst_unused:UNUSED_PAD src0_sel:DWORD src1_sel:WORD_0
    ds_read_b96 v[228:230], v231 offset:53248
    v_lshl_or_b32 v18, v23, 16, v22
    v_sub_u32 v24, v23, v22
    s_max_u32 s28, s19, 1
    s_sub_u32 s28, s28, 1
    v_readlane_b32 s44, v18, s28
    v_readlane_b32 s21, v18, 0
    s_lshr_b32 s44, s44, 16
    s_sub_u32 s29, s19, 3
    s_or_b32 s29, s29, 1
    s_sub_u32 s39, s3, s79
    s_and_b32 s39, s39, 31
    s_cmp_eq_u32 s39, 0
    s_cselect_b32 s29, s28, s29
    v_cmp_eq_u32 vcc, s28, v1
    v_cmp_eq_u32 s[74:75], s29, v1
    s_or_b64 vcc, vcc, s[74:75]
    v_or_b32 v25, 0x80000000, v18
    v_cndmask_b32 v18, v18, v25, vcc
    s_and_b32 s24, s21, 0xffff
    s_add_u32 s41, s24, 16
    s_mov_b32 s40, s24
K2_o2:
    v_mov_b32 v28, 0
    v_mov_b32 v29, 0
    v_mov_b32 v30, 0
    v_mov_b32 v31, 0
    v_lshrrev_b32 v23, 5, v1
    v_lshlrev_b32 v23, 6, v23
    v_add_u32 v23, 160864, v23
    s_mov_b32 exec_lo, 1
    s_mov_b32 exec_hi, 1
    ds_write_b128 v23, v[64:67] offset:0
    ds_write_b128 v23, v[68:71] offset:16
    ds_write_b128 v23, v[72:75] offset:32
    ds_write_b128 v23, v[76:79] offset:48
    s_mov_b64 exec, -1
    v_mov_b32 v108, 0
    v_mov_b32 v109, 0
    v_mov_b32 v110, 0
    v_mov_b32 v111, 0
    v_mov_b32 v112, 0
    v_mov_b32 v113, 0
    v_mov_b32 v114, 0
    v_mov_b32 v115, 0
K2_join:
    s_cmp_eq_u32 s19, 0
    s_cbranch_scc1 K2_nt0
    v_cmp_le_u32 vcc, 16, v24
    s_lshr_b32 s28, s24, 1
    v_mad_u32_u24 v20, v15, s28, v14
    v_subrev_u32 v11, s24, v10
    ds_read_b64_tr_b16 v[80:81], v20 offset:0
    ds_read_b64_tr_b16 v[82:83], v20 offset:544
    ds_read_b64_tr_b16 v[84:85], v20 offset:64
    ds_read_b64_tr_b16 v[86:87], v20 offset:608
    v_mfma_f32_32x32x16_bf16 v[148:163], v[28:31], v[28:31], 0
    v_mfma_f32_32x32x16_bf16 v[164:179], v[28:31], v[28:31], 0
    s_waitcnt vmcnt(0) lgkmcnt(0)
    v_mov_b32 v64, 0
    v_mov_b32 v65, 0
    v_mov_b32 v66, 0
    v_mov_b32 v67, 0
    v_mov_b32 v68, 0
    v_mov_b32 v69, 0
    v_mov_b32 v70, 0
    v_mov_b32 v71, 0
    v_mov_b32 v72, 0
    v_mov_b32 v73, 0
    v_mov_b32 v74, 0
    v_mov_b32 v75, 0
    v_mov_b32 v76, 0
    v_mov_b32 v77, 0
    v_mov_b32 v78, 0
    v_mov_b32 v79, 0
    ds_read_b128 v[88:91], v2
    ds_read_b128 v[92:95], v3
    ds_read_b128 v[96:99], v4
    ds_read_b128 v[100:103], v5
    v_mov_b32 v222, v213
    v_mov_b32 v223, v213
    ds_read_b64 v[212:213], v9
    v_add_u32 v9, 512, v9
    v_lshlrev_b32 v224, 16, v214
    v_and_b32 v225, 0xffff0000, v214
    v_lshlrev_b32 v226, 16, v215
    v_sub_f32 v224, v228, v224
    v_sub_f32 v225, v229, v225
    v_sub_f32 v226, v230, v226
    v_cvt_pk_bf16_f32 v218, v27, v224
    v_cvt_pk_bf16_f32 v219, v225, v226
    v_and_b32 v227, 0xffff0000, v218
    v_mul_f32 v227, v227, v227
    v_dot2_f32_bf16 v227, v219, v219, v227
    s_nop 2
    v_cvt_pk_bf16_f32 v221, v227, v227
    v_bfi_b32 v221, s45, v221, v222
    s_cmp_lt_i32 s42, 64
    s_cbranch_scc1 K2_san_14o
K2_san_14:
    s_sub_i32 s42, s42, 64
    s_nop 1
    v_permlane32_swap_b32 v218, v219
    v_permlane32_swap_b32 v222, v223
    v_permlane32_swap_b32 v220, v221
    s_waitcnt lgkmcnt(0)
    s_cbranch_vccnz K2_gen
    ds_read_b32 v250, v8 offset:0
    ds_read_b32 v252, v8 offset:64
    ds_read_b32 v254, v8 offset:128
    ds_read_b32 v6, v8 offset:192
    v_add_u32 v8, 256, v8
    v_add_u32_sdwa v26, v11, v222 dst_sel:DWORD dst_unused:UNUSED_PAD src0_sel:DWORD src1_sel:WORD_0
    ds_write_b16 v26, v218
    ds_write_b16_d16_hi v26, v218 offset:16
    ds_read_b128 v[104:107], v12
    v_mfma_f32_32x32x16_bf16 v[116:131], v[88:91], v[32:35], 0
    v_mfma_f32_32x32x16_bf16 v[116:131], v[92:95], v[36:39], v[116:131]
    v_mfma_f32_32x32x16_bf16 v[116:131], v[96:99], v[40:43], v[116:131]
    v_mfma_f32_32x32x16_bf16 v[116:131], v[100:103], v[44:47], v[116:131]
    s_waitcnt lgkmcnt(0)
    v_cndmask_b32 v104, v104, v220, s[30:31]
    buffer_load_dwordx4 v[250:251], s[4:7], 0 idxen offen offset:0 lds
    buffer_load_dwordx4 v[252:253], s[4:7], 0 idxen offen offset:1024 lds
    buffer_load_dwordx4 v[254:255], s[4:7], 0 idxen offen offset:2048 lds
    buffer_load_dwordx4 v[6:7], s[4:7], 0 idxen offen offset:3072 lds
    v_mfma_f32_32x32x16_bf16 v[116:131], v[104:107], v[80:83], v[116:131]
    buffer_load_dwordx2 v[214:215], v212, s[52:55], 0 idxen
    v_lshlrev_b32_sdwa v231, 3, v213 dst_sel:DWORD dst_unused:UNUSED_PAD src0_sel:DWORD src1_sel:WORD_0
    ds_read_b96 v[228:230], v231 offset:53248
    s_nop 7
    s_nop 1
    s_cmp_eq_u32 s19, 1
    s_cbranch_scc1 K2_evA_C
    .p2align 6
K2_loop:
    v_mfma_f32_32x32x16_bf16 v[132:147], v[88:91], v[48:51], 0
    v_exp_f32 v180, v116
    v_exp_f32 v181, v117
    v_exp_f32 v182, v118
    v_exp_f32 v183, v119
    v_mfma_f32_32x32x16_bf16 v[132:147], v[92:95], v[52:55], v[132:147]
    v_exp_f32 v184, v120
    v_exp_f32 v185, v121
    v_exp_f32 v186, v122
    v_exp_f32 v187, v123
    v_mfma_f32_32x32x16_bf16 v[132:147], v[96:99], v[56:59], v[132:147]
    v_exp_f32 v188, v124
    v_exp_f32 v189, v125
    v_exp_f32 v190, v126
    v_exp_f32 v191, v127
    v_mfma_f32_32x32x16_bf16 v[132:147], v[100:103], v[60:63], v[132:147]
    ds_read_b32 v250, v8 offset:0
    ds_read_b32 v252, v8 offset:64
    v_exp_f32 v192, v128
    v_exp_f32 v193, v129
    v_exp_f32 v194, v130
    v_exp_f32 v195, v131
    ds_read_b32 v254, v8 offset:128
    ds_read_b32 v6, v8 offset:192
    v_mfma_f32_32x32x8_bf16 v[180:195], v[248:249], v[248:249], v[180:195]
    v_cvt_pk_bf16_f32 v204, v64, v65
    v_cvt_pk_bf16_f32 v205, v66, v67
    v_cvt_pk_bf16_f32 v206, v68, v69
    v_cvt_pk_bf16_f32 v207, v70, v71
    v_cvt_pk_bf16_f32 v208, v72, v73
    v_cvt_pk_bf16_f32 v209, v74, v75
    v_cvt_pk_bf16_f32 v210, v76, v77
    v_cvt_pk_bf16_f32 v211, v78, v79
    v_mfma_f32_32x32x16_bf16 v[132:147], v[104:107], v[84:87], v[132:147]
    s_nop 2
    v_rcp_f32 v180, v180
    v_rcp_f32 v181, v181
    v_rcp_f32 v182, v182
    v_rcp_f32 v183, v183
    v_mfma_f32_32x32x16_bf16 v[164:179], v[204:207], v[108:111], v[164:179]
    ds_read_b64_tr_b16 v[108:109], v13 offset:0
    ds_read_b64_tr_b16 v[110:111], v13 offset:640
    v_rcp_f32 v184, v184
    v_rcp_f32 v185, v185
    v_rcp_f32 v186, v186
    v_rcp_f32 v187, v187
    s_waitcnt vmcnt(0)
    ds_read_b128 v[88:91], v2
    ds_read_b128 v[92:95], v3
    ds_read_b128 v[96:99], v4
    ds_read_b128 v[100:103], v5
    v_mfma_f32_32x32x16_bf16 v[164:179], v[208:211], v[112:115], v[164:179]
    ds_read_b64_tr_b16 v[112:113], v13 offset:1280
    ds_read_b64_tr_b16 v[114:115], v13 offset:1920
    s_add_u32 s20, s20, 1
    v_rcp_f32 v188, v188
    v_rcp_f32 v189, v189
    v_rcp_f32 v190, v190
    v_rcp_f32 v191, v191
    ds_write_b16 v26, v19
    ds_write_b16 v26, v19 offset:16
    v_rcp_f32 v192, v192
    v_rcp_f32 v193, v193
    v_rcp_f32 v194, v194
    v_rcp_f32 v195, v195
    v_pk_mul_f32 v[64:65], v[180:181], v[116:117]
    v_pk_mul_f32 v[66:67], v[182:183], v[118:119]
    v_pk_mul_f32 v[68:69], v[184:185], v[120:121]
    v_pk_mul_f32 v[70:71], v[186:187], v[122:123]
    v_pk_mul_f32 v[72:73], v[188:189], v[124:125]
    v_pk_mul_f32 v[74:75], v[190:191], v[126:127]
    v_pk_mul_f32 v[76:77], v[192:193], v[128:129]
    v_pk_mul_f32 v[78:79], v[194:195], v[130:131]
K2_nA:
    s_waitcnt lgkmcnt(0)
    v_mfma_f32_32x32x16_bf16 v[116:131], v[88:91], v[32:35], 0
    buffer_load_dwordx4 v[250:251], s[4:7], 0 idxen offen offset:0 lds
    buffer_load_dwordx4 v[252:253], s[4:7], 0 idxen offen offset:1024 lds
    v_exp_f32 v180, v132
    v_readlane_b32 s21, v18, s20
    v_exp_f32 v181, v133
    v_exp_f32 v182, v134
    v_exp_f32 v183, v135
    s_lshr_b32 s23, s21, 16
    s_cmp_ge_u32 s23, s41
    s_cbranch_scc1 K2_evB
    v_mfma_f32_32x32x16_bf16 v[116:131], v[92:95], v[36:39], v[116:131]
    v_exp_f32 v184, v136
    v_add_u32_sdwa v26, v11, v223 dst_sel:DWORD dst_unused:UNUSED_PAD src0_sel:DWORD src1_sel:WORD_0
    v_exp_f32 v185, v137
    v_exp_f32 v186, v138
    v_exp_f32 v187, v139
    ds_write_b16 v26, v219
    ds_write_b16_d16_hi v26, v219 offset:16
    v_mfma_f32_32x32x16_bf16 v[116:131], v[96:99], v[40:43], v[116:131]
    ds_read_b128 v[104:107], v12
    buffer_load_dwordx4 v[254:255], s[4:7], 0 idxen offen offset:2048 lds
    buffer_load_dwordx4 v[6:7], s[4:7], 0 idxen offen offset:3072 lds
    v_exp_f32 v188, v140
    v_exp_f32 v189, v141
    v_exp_f32 v190, v142
    v_exp_f32 v191, v143
    v_mfma_f32_32x32x16_bf16 v[116:131], v[100:103], v[44:47], v[116:131]
    v_exp_f32 v192, v144
    v_exp_f32 v193, v145
    v_exp_f32 v194, v146
    v_exp_f32 v195, v147
    s_nop 1
    v_mfma_f32_32x32x8_bf16 v[180:195], v[248:249], v[248:249], v[180:195]
    v_cvt_pk_bf16_f32 v196, v64, v65
    v_cvt_pk_bf16_f32 v197, v66, v67
    v_cvt_pk_bf16_f32 v198, v68, v69
    v_cvt_pk_bf16_f32 v199, v70, v71
    s_waitcnt lgkmcnt(0)
    v_cndmask_b32 v104, v104, v221, s[30:31]
    v_cvt_pk_bf16_f32 v200, v72, v73
    v_cvt_pk_bf16_f32 v201, v74, v75
    v_cvt_pk_bf16_f32 v202, v76, v77
    v_cvt_pk_bf16_f32 v203, v78, v79
    v_mfma_f32_32x32x16_bf16 v[116:131], v[104:107], v[80:83], v[116:131]
    s_nop 0
    v_rcp_f32 v180, v180
    v_rcp_f32 v181, v181
    v_rcp_f32 v182, v182
    v_rcp_f32 v183, v183
    v_mfma_f32_32x32x16_bf16 v[148:163], v[196:199], v[108:111], v[148:163]
    v_rcp_f32 v184, v184
    v_rcp_f32 v185, v185
    v_rcp_f32 v186, v186
    v_rcp_f32 v187, v187
    v_mfma_f32_32x32x16_bf16 v[148:163], v[200:203], v[112:115], v[148:163]
    v_rcp_f32 v188, v188
    v_rcp_f32 v189, v189
    v_rcp_f32 v190, v190
    v_rcp_f32 v191, v191
    v_rcp_f32 v192, v192
    v_rcp_f32 v193, v193
    v_rcp_f32 v194, v194
    v_rcp_f32 v195, v195
    v_pk_mul_f32 v[64:65], v[180:181], v[132:133]
    v_pk_mul_f32 v[66:67], v[182:183], v[134:135]
    v_pk_mul_f32 v[68:69], v[184:185], v[136:137]
    v_pk_mul_f32 v[70:71], v[186:187], v[138:139]
    v_pk_mul_f32 v[72:73], v[188:189], v[140:141]
    v_pk_mul_f32 v[74:75], v[190:191], v[142:143]
    v_pk_mul_f32 v[76:77], v[192:193], v[144:145]
    v_pk_mul_f32 v[78:79], v[194:195], v[146:147]
    v_mfma_f32_32x32x16_bf16 v[132:147], v[88:91], v[48:51], 0
    v_exp_f32 v180, v116
    v_mov_b32 v222, v213
    v_mov_b32 v223, v213
    v_exp_f32 v181, v117
    v_lshlrev_b32 v224, 16, v214
    v_and_b32 v225, 0xffff0000, v214
    v_exp_f32 v182, v118
    v_lshlrev_b32 v226, 16, v215
    v_exp_f32 v183, v119
    ds_read_b64 v[212:213], v9
    v_mfma_f32_32x32x16_bf16 v[132:147], v[92:95], v[52:55], v[132:147]
    v_exp_f32 v184, v120
    v_add_u32 v9, 512, v9
    v_sub_f32 v224, v228, v224
    v_sub_f32 v225, v229, v225
    v_sub_f32 v226, v230, v226
    v_exp_f32 v185, v121
    v_exp_f32 v186, v122
    v_cvt_pk_bf16_f32 v218, v27, v224
    v_cvt_pk_bf16_f32 v219, v225, v226
    v_exp_f32 v187, v123
    v_mfma_f32_32x32x16_bf16 v[132:147], v[96:99], v[56:59], v[132:147]
    v_exp_f32 v188, v124
    v_exp_f32 v189, v125
    v_and_b32 v227, 0xffff0000, v218
    v_mul_f32 v227, v227, v227
    v_exp_f32 v190, v126
    v_exp_f32 v191, v127
    v_dot2_f32_bf16 v227, v219, v219, v227
    v_mfma_f32_32x32x16_bf16 v[132:147], v[100:103], v[60:63], v[132:147]
    ds_read_b32 v250, v8 offset:256
    ds_read_b32 v252, v8 offset:320
    v_exp_f32 v192, v128
    v_exp_f32 v193, v129
    v_exp_f32 v194, v130
    v_cvt_pk_bf16_f32 v221, v227, v227
    v_bfi_b32 v221, s45, v221, v222
    v_exp_f32 v195, v131
    ds_read_b32 v254, v8 offset:384
    ds_read_b32 v6, v8 offset:448
    v_mfma_f32_32x32x8_bf16 v[180:195], v[248:249], v[248:249], v[180:195]
    v_cvt_pk_bf16_f32 v204, v64, v65
    v_cvt_pk_bf16_f32 v205, v66, v67
    v_cvt_pk_bf16_f32 v206, v68, v69
    v_cvt_pk_bf16_f32 v207, v70, v71
    v_cvt_pk_bf16_f32 v208, v72, v73
    v_cvt_pk_bf16_f32 v209, v74, v75
    v_cvt_pk_bf16_f32 v210, v76, v77
    v_cvt_pk_bf16_f32 v211, v78, v79
    v_mfma_f32_32x32x16_bf16 v[132:147], v[104:107], v[84:87], v[132:147]
    s_nop 2
    v_rcp_f32 v180, v180
    v_add_u32 v8, 512, v8
    v_rcp_f32 v181, v181
    v_rcp_f32 v182, v182
    v_permlane32_swap_b32 v218, v219
    v_permlane32_swap_b32 v222, v223
    v_rcp_f32 v183, v183
    v_mfma_f32_32x32x16_bf16 v[164:179], v[204:207], v[108:111], v[164:179]
    ds_read_b64_tr_b16 v[108:109], v13 offset:0
    ds_read_b64_tr_b16 v[110:111], v13 offset:640
    v_rcp_f32 v184, v184
    v_rcp_f32 v185, v185
    v_permlane32_swap_b32 v220, v221
    v_rcp_f32 v186, v186
    v_rcp_f32 v187, v187
    s_waitcnt vmcnt(0)
    ds_read_b128 v[88:91], v2
    ds_read_b128 v[92:95], v3
    ds_read_b128 v[96:99], v4
    ds_read_b128 v[100:103], v5
    v_mfma_f32_32x32x16_bf16 v[164:179], v[208:211], v[112:115], v[164:179]
    ds_read_b64_tr_b16 v[112:113], v13 offset:1280
    ds_read_b64_tr_b16 v[114:115], v13 offset:1920
    s_add_u32 s20, s20, 1
    v_rcp_f32 v188, v188
    v_rcp_f32 v189, v189
    v_rcp_f32 v190, v190
    v_rcp_f32 v191, v191
    ds_write_b16 v26, v19
    ds_write_b16 v26, v19 offset:16
    v_rcp_f32 v192, v192
    v_rcp_f32 v193, v193
    v_rcp_f32 v194, v194
    v_rcp_f32 v195, v195
    v_pk_mul_f32 v[64:65], v[180:181], v[116:117]
    v_pk_mul_f32 v[66:67], v[182:183], v[118:119]
    v_pk_mul_f32 v[68:69], v[184:185], v[120:121]
    v_pk_mul_f32 v[70:71], v[186:187], v[122:123]
    v_pk_mul_f32 v[72:73], v[188:189], v[124:125]
    v_pk_mul_f32 v[74:75], v[190:191], v[126:127]
    v_pk_mul_f32 v[76:77], v[192:193], v[128:129]
    v_pk_mul_f32 v[78:79], v[194:195], v[130:131]
K2_nB:
    s_waitcnt lgkmcnt(0)
    v_mfma_f32_32x32x16_bf16 v[116:131], v[88:91], v[32:35], 0
    buffer_load_dwordx4 v[250:251], s[4:7], 0 idxen offen offset:0 lds
    buffer_load_dwordx4 v[252:253], s[4:7], 0 idxen offen offset:1024 lds
    v_exp_f32 v180, v132
    v_readlane_b32 s21, v18, s20
    v_exp_f32 v181, v133
    v_exp_f32 v182, v134
    v_exp_f32 v183, v135
    s_lshr_b32 s23, s21, 16
    s_cmp_ge_u32 s23, s41
    s_cbranch_scc1 K2_evA
    v_mfma_f32_32x32x16_bf16 v[116:131], v[92:95], v[36:39], v[116:131]
    v_exp_f32 v184, v136
    v_add_u32_sdwa v26, v11, v222 dst_sel:DWORD dst_unused:UNUSED_PAD src0_sel:DWORD src1_sel:WORD_0
    v_exp_f32 v185, v137
    v_exp_f32 v186, v138
    v_exp_f32 v187, v139
    ds_write_b16 v26, v218
    ds_write_b16_d16_hi v26, v218 offset:16
    v_mfma_f32_32x32x16_bf16 v[116:131], v[96:99], v[40:43], v[116:131]
    ds_read_b128 v[104:107], v12
    buffer_load_dwordx4 v[254:255], s[4:7], 0 idxen offen offset:2048 lds
    buffer_load_dwordx4 v[6:7], s[4:7], 0 idxen offen offset:3072 lds
    v_exp_f32 v188, v140
    v_exp_f32 v189, v141
    v_exp_f32 v190, v142
    v_exp_f32 v191, v143
    v_mfma_f32_32x32x16_bf16 v[116:131], v[100:103], v[44:47], v[116:131]
    v_exp_f32 v192, v144
    v_lshlrev_b32_sdwa v231, 3, v213 dst_sel:DWORD dst_unused:UNUSED_PAD src0_sel:DWORD src1_sel:WORD_0
    v_exp_f32 v193, v145
    v_exp_f32 v194, v146
    v_exp_f32 v195, v147
    buffer_load_dwordx2 v[214:215], v212, s[52:55], 0 idxen
    ds_read_b96 v[228:230], v231 offset:53248
    v_mfma_f32_32x32x8_bf16 v[180:195], v[248:249], v[248:249], v[180:195]
    v_cvt_pk_bf16_f32 v196, v64, v65
    v_cvt_pk_bf16_f32 v197, v66, v67
    v_cvt_pk_bf16_f32 v198, v68, v69
    v_cvt_pk_bf16_f32 v199, v70, v71
    s_waitcnt lgkmcnt(1)
    v_cndmask_b32 v104, v104, v220, s[30:31]
    v_cvt_pk_bf16_f32 v200, v72, v73
    v_cvt_pk_bf16_f32 v201, v74, v75
    v_cvt_pk_bf16_f32 v202, v76, v77
    v_cvt_pk_bf16_f32 v203, v78, v79
    v_mfma_f32_32x32x16_bf16 v[116:131], v[104:107], v[80:83], v[116:131]
    s_nop 0
    v_rcp_f32 v180, v180
    v_rcp_f32 v181, v181
    v_rcp_f32 v182, v182
    v_rcp_f32 v183, v183
    v_mfma_f32_32x32x16_bf16 v[148:163], v[196:199], v[108:111], v[148:163]
    v_rcp_f32 v184, v184
    v_rcp_f32 v185, v185
    v_rcp_f32 v186, v186
    v_rcp_f32 v187, v187
    v_mfma_f32_32x32x16_bf16 v[148:163], v[200:203], v[112:115], v[148:163]
    v_rcp_f32 v188, v188
    v_rcp_f32 v189, v189
    v_rcp_f32 v190, v190
    v_rcp_f32 v191, v191
    v_rcp_f32 v192, v192
    v_rcp_f32 v193, v193
    v_rcp_f32 v194, v194
    v_rcp_f32 v195, v195
    v_pk_mul_f32 v[64:65], v[180:181], v[132:133]
    v_pk_mul_f32 v[66:67], v[182:183], v[134:135]
    v_pk_mul_f32 v[68:69], v[184:185], v[136:137]
    v_pk_mul_f32 v[70:71], v[186:187], v[138:139]
    v_pk_mul_f32 v[72:73], v[188:189], v[140:141]
    v_pk_mul_f32 v[74:75], v[190:191], v[142:143]
    v_pk_mul_f32 v[76:77], v[192:193], v[144:145]
    v_pk_mul_f32 v[78:79], v[194:195], v[146:147]
    s_branch K2_loop
    .p2align 6
K2_evB:
    s_bitcmp1_b32 s23, 15
    s_cbranch_scc1 K2_evlB
    s_mov_b32 s40, s24
    s_and_b32 s24, s21, 0xffff
    s_add_u32 s41, s24, 16
    s_lshr_b32 s28, s24, 1
    v_mad_u32_u24 v20, v15, s28, v14
    v_subrev_u32 v11, s24, v10
    ds_read_b64_tr_b16 v[80:81], v20 offset:0
    ds_read_b64_tr_b16 v[82:83], v20 offset:544
    ds_read_b64_tr_b16 v[84:85], v20 offset:64
    ds_read_b64_tr_b16 v[86:87], v20 offset:608
    v_mfma_f32_32x32x16_bf16 v[116:131], v[92:95], v[36:39], v[116:131]
    v_exp_f32 v184, v136
    v_add_u32_sdwa v26, v11, v223 dst_sel:DWORD dst_unused:UNUSED_PAD src0_sel:DWORD src1_sel:WORD_0
    v_exp_f32 v185, v137
    v_exp_f32 v186, v138
    v_exp_f32 v187, v139
    ds_write_b16 v26, v219
    ds_write_b16_d16_hi v26, v219 offset:16
    v_mfma_f32_32x32x16_bf16 v[116:131], v[96:99], v[40:43], v[116:131]
    ds_read_b128 v[104:107], v12
    buffer_load_dwordx4 v[254:255], s[4:7], 0 idxen offen offset:2048 lds
    buffer_load_dwordx4 v[6:7], s[4:7], 0 idxen offen offset:3072 lds
    v_exp_f32 v188, v140
    v_exp_f32 v189, v141
    v_exp_f32 v190, v142
    v_exp_f32 v191, v143
    v_mfma_f32_32x32x16_bf16 v[116:131], v[100:103], v[44:47], v[116:131]
    v_exp_f32 v192, v144
    v_exp_f32 v193, v145
    v_exp_f32 v194, v146
    v_exp_f32 v195, v147
    s_nop 1
    v_mfma_f32_32x32x8_bf16 v[180:195], v[248:249], v[248:249], v[180:195]
    v_cvt_pk_bf16_f32 v196, v64, v65
    v_cvt_pk_bf16_f32 v197, v66, v67
    v_cvt_pk_bf16_f32 v198, v68, v69
    v_cvt_pk_bf16_f32 v199, v70, v71
    s_waitcnt lgkmcnt(0)
    v_cndmask_b32 v104, v104, v221, s[30:31]
    v_cvt_pk_bf16_f32 v200, v72, v73
    v_cvt_pk_bf16_f32 v201, v74, v75
    v_cvt_pk_bf16_f32 v202, v76, v77
    v_cvt_pk_bf16_f32 v203, v78, v79
    v_mfma_f32_32x32x16_bf16 v[116:131], v[104:107], v[80:83], v[116:131]
    s_nop 0
    v_rcp_f32 v180, v180
    v_rcp_f32 v181, v181
    v_rcp_f32 v182, v182
    v_rcp_f32 v183, v183
    v_mfma_f32_32x32x16_bf16 v[148:163], v[196:199], v[108:111], v[148:163]
    v_rcp_f32 v184, v184
    v_rcp_f32 v185, v185
    v_rcp_f32 v186, v186
    v_rcp_f32 v187, v187
    v_mfma_f32_32x32x16_bf16 v[148:163], v[200:203], v[112:115], v[148:163]
    v_rcp_f32 v188, v188
    v_rcp_f32 v189, v189
    v_rcp_f32 v190, v190
    v_rcp_f32 v191, v191
    v_rcp_f32 v192, v192
    v_rcp_f32 v193, v193
    v_rcp_f32 v194, v194
    v_rcp_f32 v195, v195
    v_pk_mul_f32 v[64:65], v[180:181], v[132:133]
    v_pk_mul_f32 v[66:67], v[182:183], v[134:135]
    v_pk_mul_f32 v[68:69], v[184:185], v[136:137]
    v_pk_mul_f32 v[70:71], v[186:187], v[138:139]
    v_pk_mul_f32 v[72:73], v[188:189], v[140:141]
    v_pk_mul_f32 v[74:75], v[190:191], v[142:143]
    v_pk_mul_f32 v[76:77], v[192:193], v[144:145]
    v_pk_mul_f32 v[78:79], v[194:195], v[146:147]
    v_mfma_f32_32x32x16_bf16 v[132:147], v[88:91], v[48:51], 0
    v_exp_f32 v180, v116
    v_mov_b32 v222, v213
    v_mov_b32 v223, v213
    v_exp_f32 v181, v117
    v_lshlrev_b32 v224, 16, v214
    v_and_b32 v225, 0xffff0000, v214
    v_exp_f32 v182, v118
    v_lshlrev_b32 v226, 16, v215
    v_exp_f32 v183, v119
    ds_read_b64 v[212:213], v9
    v_mfma_f32_32x32x16_bf16 v[132:147], v[92:95], v[52:55], v[132:147]
    v_exp_f32 v184, v120
    v_add_u32 v9, 512, v9
    v_sub_f32 v224, v228, v224
    v_sub_f32 v225, v229, v225
    v_sub_f32 v226, v230, v226
    v_exp_f32 v185, v121
    v_exp_f32 v186, v122
    v_cvt_pk_bf16_f32 v218, v27, v224
    v_cvt_pk_bf16_f32 v219, v225, v226
    v_exp_f32 v187, v123
    v_mfma_f32_32x32x16_bf16 v[132:147], v[96:99], v[56:59], v[132:147]
    v_exp_f32 v188, v124
    v_exp_f32 v189, v125
    v_and_b32 v227, 0xffff0000, v218
    v_mul_f32 v227, v227, v227
    v_exp_f32 v190, v126
    v_exp_f32 v191, v127
    v_dot2_f32_bf16 v227, v219, v219, v227
    v_mfma_f32_32x32x16_bf16 v[132:147], v[100:103], v[60:63], v[132:147]
    ds_read_b32 v250, v8 offset:256
    ds_read_b32 v252, v8 offset:320
    v_exp_f32 v192, v128
    v_exp_f32 v193, v129
    v_exp_f32 v194, v130
    v_cvt_pk_bf16_f32 v221, v227, v227
    v_bfi_b32 v221, s45, v221, v222
    v_exp_f32 v195, v131
    ds_read_b32 v254, v8 offset:384
    ds_read_b32 v6, v8 offset:448
    v_mfma_f32_32x32x8_bf16 v[180:195], v[248:249], v[248:249], v[180:195]
    v_cvt_pk_bf16_f32 v204, v64, v65
    v_cvt_pk_bf16_f32 v205, v66, v67
    v_cvt_pk_bf16_f32 v206, v68, v69
    v_cvt_pk_bf16_f32 v207, v70, v71
    v_cvt_pk_bf16_f32 v208, v72, v73
    v_cvt_pk_bf16_f32 v209, v74, v75
    v_cvt_pk_bf16_f32 v210, v76, v77
    v_cvt_pk_bf16_f32 v211, v78, v79
    v_mfma_f32_32x32x16_bf16 v[132:147], v[104:107], v[84:87], v[132:147]
    s_nop 2
    v_rcp_f32 v180, v180
    v_add_u32 v8, 512, v8
    v_rcp_f32 v181, v181
    v_rcp_f32 v182, v182
    v_permlane32_swap_b32 v218, v219
    v_permlane32_swap_b32 v222, v223
    v_rcp_f32 v183, v183
    v_mfma_f32_32x32x16_bf16 v[164:179], v[204:207], v[108:111], v[164:179]
    ds_read_b64_tr_b16 v[108:109], v13 offset:0
    ds_read_b64_tr_b16 v[110:111], v13 offset:640
    v_rcp_f32 v184, v184
    v_rcp_f32 v185, v185
    v_permlane32_swap_b32 v220, v221
    v_rcp_f32 v186, v186
    v_rcp_f32 v187, v187
    s_waitcnt vmcnt(0)
    ds_read_b128 v[88:91], v2
    ds_read_b128 v[92:95], v3
    ds_read_b128 v[96:99], v4
    ds_read_b128 v[100:103], v5
    v_mfma_f32_32x32x16_bf16 v[164:179], v[208:211], v[112:115], v[164:179]
    ds_read_b64_tr_b16 v[112:113], v13 offset:1280
    ds_read_b64_tr_b16 v[114:115], v13 offset:1920
    s_add_u32 s20, s20, 1
    v_rcp_f32 v188, v188
    v_rcp_f32 v189, v189
    v_rcp_f32 v190, v190
    v_rcp_f32 v191, v191
    ds_write_b16 v26, v19
    ds_write_b16 v26, v19 offset:16
    v_rcp_f32 v192, v192
    ds_read_b128 v[196:199], v23 offset:0
    ds_read_b128 v[200:203], v23 offset:16
    ds_read_b128 v[204:207], v23 offset:32
    ds_read_b128 v[208:211], v23 offset:48
    v_rcp_f32 v193, v193
    v_rcp_f32 v194, v194
    v_rcp_f32 v195, v195
    v_pk_mul_f32 v[64:65], v[180:181], v[116:117]
    v_pk_mul_f32 v[66:67], v[182:183], v[118:119]
    v_pk_mul_f32 v[68:69], v[184:185], v[120:121]
    v_pk_mul_f32 v[70:71], v[186:187], v[122:123]
    v_pk_mul_f32 v[72:73], v[188:189], v[124:125]
    v_pk_mul_f32 v[74:75], v[190:191], v[126:127]
    v_pk_mul_f32 v[76:77], v[192:193], v[128:129]
    v_pk_mul_f32 v[78:79], v[194:195], v[130:131]
    v_cvt_pk_bf16_f32 v180, v148, v149
    v_cvt_pk_bf16_f32 v181, v150, v151
    s_lshr_b32 s28, s40, 1
    v_cvt_pk_bf16_f32 v182, v152, v153
    v_cvt_pk_bf16_f32 v183, v154, v155
    s_mul_i32 s29, s28, 136
    v_cvt_pk_bf16_f32 v184, v156, v157
    v_cvt_pk_bf16_f32 v185, v158, v159
    s_lshl_b32 s39, s28, 4
    s_waitcnt lgkmcnt(0)
    v_mfma_f32_32x32x16_bf16 v[116:131], v[196:199], v[180:183], 0
    v_cvt_pk_bf16_f32 v186, v160, v161
    s_sub_u32 s28, s78, s28
    v_cvt_pk_bf16_f32 v187, v162, v163
    s_min_u32 s28, s28, 8
    v_cvt_pk_bf16_f32 v188, v164, v165
    v_cvt_pk_bf16_f32 v189, v166, v167
    s_bfm_b32 s28, s28, 0
    v_mfma_f32_32x32x16_bf16 v[116:131], v[200:203], v[184:187], v[116:131]
    v_cvt_pk_bf16_f32 v190, v168, v169
    v_cvt_pk_bf16_f32 v191, v170, v171
    v_cvt_pk_bf16_f32 v192, v172, v173
    v_cvt_pk_bf16_f32 v193, v174, v175
    v_mfma_f32_32x32x16_bf16 v[116:131], v[204:207], v[188:191], v[116:131]
    v_cvt_pk_bf16_f32 v194, v176, v177
    v_cvt_pk_bf16_f32 v195, v178, v179
    v_add_u32 v20, s29, v16
    s_mov_b64 exec, s[56:57]
    v_add_u32 v20, s58, v16
    s_mov_b64 exec, -1
    v_add_u32 v21, s39, v17
    s_add_u32 s60, s29, 85760
    s_cmp_lg_u32 s56, 0
    s_cselect_b32 s60, s59, s60
    s_mov_b64 s[56:57], 0
    s_mul_i32 s29, s28, 0x01010100
    v_mfma_f32_32x32x16_bf16 v[116:131], v[208:211], v[192:195], v[116:131]
    v_mfma_f32_32x32x16_bf16 v[148:163], v[28:31], v[28:31], 0
    v_mfma_f32_32x32x16_bf16 v[164:179], v[28:31], v[28:31], 0
    s_mov_b32 exec_lo, s28
    s_mov_b32 exec_hi, s28
    ds_write2_b64 v20, v[180:181], v[182:183] offset0:0 offset1:2
    ds_write2_b64 v20, v[184:185], v[186:187] offset0:4 offset1:6
    ds_write2_b64 v20, v[188:189], v[190:191] offset0:8 offset1:10
    ds_write2_b64 v20, v[192:193], v[194:195] offset0:12 offset1:14
    s_mov_b64 exec, -1
    s_or_b32 s76, s29, 1
    s_mov_b32 s77, 0
    s_mov_b32 s43, 0
    s_nop 3
    v_writelane_b32 v116, s60, 0
    s_mov_b64 exec, s[76:77]
    ds_write_b32 v21, v116
    s_mov_b64 exec, -1
    s_mov_b64 s[76:77], 0
    s_branch K2_nB
    .p2align 6
K2_evlB:
    s_and_b32 s23, s23, 0x7fff
    s_cmp_ge_u32 s23, s41
    s_cbranch_scc0 K2_evs_6015
    s_mov_b32 s40, s24
    s_and_b32 s24, s21, 0xffff
    s_add_u32 s41, s24, 16
    s_mov_b32 s43, 1
    s_lshr_b32 s28, s24, 1
    v_mad_u32_u24 v20, v15, s28, v14
    v_subrev_u32 v11, s24, v10
    ds_read_b64_tr_b16 v[80:81], v20 offset:0
    ds_read_b64_tr_b16 v[82:83], v20 offset:544
    ds_read_b64_tr_b16 v[84:85], v20 offset:64
    ds_read_b64_tr_b16 v[86:87], v20 offset:608
K2_evs_6015:
    v_mfma_f32_32x32x16_bf16 v[116:131], v[92:95], v[36:39], v[116:131]
    v_exp_f32 v184, v136
    v_add_u32_sdwa v26, v11, v223 dst_sel:DWORD dst_unused:UNUSED_PAD src0_sel:DWORD src1_sel:WORD_0
    v_exp_f32 v185, v137
    v_exp_f32 v186, v138
    v_exp_f32 v187, v139
    ds_write_b16 v26, v219
    ds_write_b16_d16_hi v26, v219 offset:16
    v_mfma_f32_32x32x16_bf16 v[116:131], v[96:99], v[40:43], v[116:131]
    ds_read_b128 v[104:107], v12
    buffer_load_dwordx4 v[254:255], s[4:7], 0 idxen offen offset:2048 lds
    buffer_load_dwordx4 v[6:7], s[4:7], 0 idxen offen offset:3072 lds
    v_exp_f32 v188, v140
    v_exp_f32 v189, v141
    v_exp_f32 v190, v142
    v_exp_f32 v191, v143
    v_mfma_f32_32x32x16_bf16 v[116:131], v[100:103], v[44:47], v[116:131]
    v_exp_f32 v192, v144
    v_exp_f32 v193, v145
    v_exp_f32 v194, v146
    v_exp_f32 v195, v147
    s_nop 1
    v_mfma_f32_32x32x8_bf16 v[180:195], v[248:249], v[248:249], v[180:195]
    v_cvt_pk_bf16_f32 v196, v64, v65
    v_cvt_pk_bf16_f32 v197, v66, v67
    v_cvt_pk_bf16_f32 v198, v68, v69
    v_cvt_pk_bf16_f32 v199, v70, v71
    s_waitcnt lgkmcnt(0)
    v_cndmask_b32 v104, v104, v221, s[30:31]
    v_cvt_pk_bf16_f32 v200, v72, v73
    v_cvt_pk_bf16_f32 v201, v74, v75
    v_cvt_pk_bf16_f32 v202, v76, v77
    v_cvt_pk_bf16_f32 v203, v78, v79
    v_mfma_f32_32x32x16_bf16 v[116:131], v[104:107], v[80:83], v[116:131]
    s_nop 0
    v_rcp_f32 v180, v180
    v_rcp_f32 v181, v181
    v_rcp_f32 v182, v182
    v_rcp_f32 v183, v183
    v_mfma_f32_32x32x16_bf16 v[148:163], v[196:199], v[108:111], v[148:163]
    v_rcp_f32 v184, v184
    v_rcp_f32 v185, v185
    v_rcp_f32 v186, v186
    v_rcp_f32 v187, v187
    v_mfma_f32_32x32x16_bf16 v[148:163], v[200:203], v[112:115], v[148:163]
    v_rcp_f32 v188, v188
    v_rcp_f32 v189, v189
    v_rcp_f32 v190, v190
    v_rcp_f32 v191, v191
    v_rcp_f32 v192, v192
    v_rcp_f32 v193, v193
    v_rcp_f32 v194, v194
    v_rcp_f32 v195, v195
    v_pk_mul_f32 v[64:65], v[180:181], v[132:133]
    v_pk_mul_f32 v[66:67], v[182:183], v[134:135]
    v_pk_mul_f32 v[68:69], v[184:185], v[136:137]
    v_pk_mul_f32 v[70:71], v[186:187], v[138:139]
    v_pk_mul_f32 v[72:73], v[188:189], v[140:141]
    v_pk_mul_f32 v[74:75], v[190:191], v[142:143]
    v_pk_mul_f32 v[76:77], v[192:193], v[144:145]
    v_pk_mul_f32 v[78:79], v[194:195], v[146:147]
K2_evB_C:
    v_mfma_f32_32x32x16_bf16 v[132:147], v[88:91], v[48:51], 0
    v_exp_f32 v180, v116
    v_mov_b32 v222, v213
    v_mov_b32 v223, v213
    v_exp_f32 v181, v117
    v_lshlrev_b32 v224, 16, v214
    v_and_b32 v225, 0xffff0000, v214
    v_exp_f32 v182, v118
    v_lshlrev_b32 v226, 16, v215
    v_exp_f32 v183, v119
    ds_read_b64 v[212:213], v9
    v_mfma_f32_32x32x16_bf16 v[132:147], v[92:95], v[52:55], v[132:147]
    v_exp_f32 v184, v120
    v_add_u32 v9, 512, v9
    v_sub_f32 v224, v228, v224
    v_sub_f32 v225, v229, v225
    v_sub_f32 v226, v230, v226
    v_exp_f32 v185, v121
    v_exp_f32 v186, v122
    v_cvt_pk_bf16_f32 v218, v27, v224
    v_cvt_pk_bf16_f32 v219, v225, v226
    v_exp_f32 v187, v123
    v_mfma_f32_32x32x16_bf16 v[132:147], v[96:99], v[56:59], v[132:147]
    v_exp_f32 v188, v124
    v_exp_f32 v189, v125
    v_and_b32 v227, 0xffff0000, v218
    v_mul_f32 v227, v227, v227
    v_exp_f32 v190, v126
    v_exp_f32 v191, v127
    v_dot2_f32_bf16 v227, v219, v219, v227
    v_mfma_f32_32x32x16_bf16 v[132:147], v[100:103], v[60:63], v[132:147]
    ds_read_b32 v250, v8 offset:256
    ds_read_b32 v252, v8 offset:320
    v_exp_f32 v192, v128
    v_exp_f32 v193, v129
    v_exp_f32 v194, v130
    v_cvt_pk_bf16_f32 v221, v227, v227
    v_bfi_b32 v221, s45, v221, v222
    v_exp_f32 v195, v131
    ds_read_b32 v254, v8 offset:384
    ds_read_b32 v6, v8 offset:448
    v_mfma_f32_32x32x8_bf16 v[180:195], v[248:249], v[248:249], v[180:195]
    v_cvt_pk_bf16_f32 v204, v64, v65
    v_cvt_pk_bf16_f32 v205, v66, v67
    v_cvt_pk_bf16_f32 v206, v68, v69
    v_cvt_pk_bf16_f32 v207, v70, v71
    v_cvt_pk_bf16_f32 v208, v72, v73
    v_cvt_pk_bf16_f32 v209, v74, v75
    v_cvt_pk_bf16_f32 v210, v76, v77
    v_cvt_pk_bf16_f32 v211, v78, v79
    s_lshl_b32 s29, s20, 5
    s_sub_i32 s29, s42, s29
    s_add_i32 s29, s29, 32
    s_cmp_lt_i32 s29, 64
    s_cbranch_scc0 K2_sane_6016
    s_max_i32 s28, s29, 0
    v_cmp_gt_u32 s[74:75], s28, v1
    v_mov_b32 v229, s44
    s_nop 0
    v_cndmask_b32 v218, v19, v218, s[74:75]
    v_cndmask_b32 v219, v19, v219, s[74:75]
    v_cndmask_b32 v221, v19, v221, s[74:75]
    v_cndmask_b32 v222, v229, v222, s[74:75]
    v_mov_b32 v223, v222
    s_nop 0
K2_sane_6016:
    v_mfma_f32_32x32x16_bf16 v[132:147], v[104:107], v[84:87], v[132:147]
    v_rcp_f32 v180, v180
    v_add_u32 v8, 512, v8
    v_rcp_f32 v181, v181
    v_rcp_f32 v182, v182
    v_permlane32_swap_b32 v218, v219
    v_permlane32_swap_b32 v222, v223
    v_rcp_f32 v183, v183
    v_mfma_f32_32x32x16_bf16 v[164:179], v[204:207], v[108:111], v[164:179]
    ds_read_b64_tr_b16 v[108:109], v13 offset:0
    ds_read_b64_tr_b16 v[110:111], v13 offset:640
    v_rcp_f32 v184, v184
    v_rcp_f32 v185, v185
    v_permlane32_swap_b32 v220, v221
    v_rcp_f32 v186, v186
    v_rcp_f32 v187, v187
    s_waitcnt vmcnt(0)
    ds_read_b128 v[88:91], v2
    ds_read_b128 v[92:95], v3
    ds_read_b128 v[96:99], v4
    ds_read_b128 v[100:103], v5
    v_mfma_f32_32x32x16_bf16 v[164:179], v[208:211], v[112:115], v[164:179]
    ds_read_b64_tr_b16 v[112:113], v13 offset:1280
    ds_read_b64_tr_b16 v[114:115], v13 offset:1920
    s_add_u32 s20, s20, 1
    v_rcp_f32 v188, v188
    v_rcp_f32 v189, v189
    v_rcp_f32 v190, v190
    v_rcp_f32 v191, v191
    ds_write_b16 v26, v19
    ds_write_b16 v26, v19 offset:16
    v_rcp_f32 v192, v192
    ds_read_b128 v[196:199], v23 offset:0
    ds_read_b128 v[200:203], v23 offset:16
    ds_read_b128 v[204:207], v23 offset:32
    ds_read_b128 v[208:211], v23 offset:48
    v_rcp_f32 v193, v193
    v_rcp_f32 v194, v194
    v_rcp_f32 v195, v195
    v_pk_mul_f32 v[64:65], v[180:181], v[116:117]
    v_pk_mul_f32 v[66:67], v[182:183], v[118:119]
    v_pk_mul_f32 v[68:69], v[184:185], v[120:121]
    v_pk_mul_f32 v[70:71], v[186:187], v[122:123]
    v_pk_mul_f32 v[72:73], v[188:189], v[124:125]
    v_pk_mul_f32 v[74:75], v[190:191], v[126:127]
    v_pk_mul_f32 v[76:77], v[192:193], v[128:129]
    v_pk_mul_f32 v[78:79], v[194:195], v[130:131]
    s_cmp_eq_u32 s43, 0
    s_cbranch_scc1 K2_evf_6017
    v_cvt_pk_bf16_f32 v180, v148, v149
    v_cvt_pk_bf16_f32 v181, v150, v151
    s_lshr_b32 s28, s40, 1
    v_cvt_pk_bf16_f32 v182, v152, v153
    v_cvt_pk_bf16_f32 v183, v154, v155
    s_mul_i32 s29, s28, 136
    v_cvt_pk_bf16_f32 v184, v156, v157
    v_cvt_pk_bf16_f32 v185, v158, v159
    s_lshl_b32 s39, s28, 4
    s_waitcnt lgkmcnt(0)
    v_mfma_f32_32x32x16_bf16 v[116:131], v[196:199], v[180:183], 0
    v_cvt_pk_bf16_f32 v186, v160, v161
    s_sub_u32 s28, s78, s28
    v_cvt_pk_bf16_f32 v187, v162, v163
    s_min_u32 s28, s28, 8
    v_cvt_pk_bf16_f32 v188, v164, v165
    v_cvt_pk_bf16_f32 v189, v166, v167
    s_bfm_b32 s28, s28, 0
    v_mfma_f32_32x32x16_bf16 v[116:131], v[200:203], v[184:187], v[116:131]
    v_cvt_pk_bf16_f32 v190, v168, v169
    v_cvt_pk_bf16_f32 v191, v170, v171
    v_cvt_pk_bf16_f32 v192, v172, v173
    v_cvt_pk_bf16_f32 v193, v174, v175
    v_mfma_f32_32x32x16_bf16 v[116:131], v[204:207], v[188:191], v[116:131]
    v_cvt_pk_bf16_f32 v194, v176, v177
    v_cvt_pk_bf16_f32 v195, v178, v179
    v_add_u32 v20, s29, v16
    s_mov_b64 exec, s[56:57]
    v_add_u32 v20, s58, v16
    s_mov_b64 exec, -1
    v_add_u32 v21, s39, v17
    s_add_u32 s60, s29, 85760
    s_cmp_lg_u32 s56, 0
    s_cselect_b32 s60, s59, s60
    s_mov_b64 s[56:57], 0
    s_mul_i32 s29, s28, 0x01010100
    v_mfma_f32_32x32x16_bf16 v[116:131], v[208:211], v[192:195], v[116:131]
    v_mfma_f32_32x32x16_bf16 v[148:163], v[28:31], v[28:31], 0
    v_mfma_f32_32x32x16_bf16 v[164:179], v[28:31], v[28:31], 0
    s_mov_b32 exec_lo, s28
    s_mov_b32 exec_hi, s28
    ds_write2_b64 v20, v[180:181], v[182:183] offset0:0 offset1:2
    ds_write2_b64 v20, v[184:185], v[186:187] offset0:4 offset1:6
    ds_write2_b64 v20, v[188:189], v[190:191] offset0:8 offset1:10
    ds_write2_b64 v20, v[192:193], v[194:195] offset0:12 offset1:14
    s_mov_b64 exec, -1
    s_or_b32 s76, s29, 1
    s_mov_b32 s77, 0
    s_mov_b32 s43, 0
    s_nop 3
    v_writelane_b32 v116, s60, 0
    s_mov_b64 exec, s[76:77]
    ds_write_b32 v21, v116
    s_mov_b64 exec, -1
    s_mov_b64 s[76:77], 0
K2_evf_6017:
    s_cmp_ge_u32 s20, s19
    s_cbranch_scc1 K2_fin
    s_branch K2_nB
    .p2align 6
K2_evA:
    s_bitcmp1_b32 s23, 15
    s_cbranch_scc1 K2_evlA
    s_mov_b32 s40, s24
    s_and_b32 s24, s21, 0xffff
    s_add_u32 s41, s24, 16
    s_lshr_b32 s28, s24, 1
    v_mad_u32_u24 v20, v15, s28, v14
    v_subrev_u32 v11, s24, v10
    ds_read_b64_tr_b16 v[80:81], v20 offset:0
    ds_read_b64_tr_b16 v[82:83], v20 offset:544
    ds_read_b64_tr_b16 v[84:85], v20 offset:64
    ds_read_b64_tr_b16 v[86:87], v20 offset:608
    v_mfma_f32_32x32x16_bf16 v[116:131], v[92:95], v[36:39], v[116:131]
    v_exp_f32 v184, v136
    v_add_u32_sdwa v26, v11, v222 dst_sel:DWORD dst_unused:UNUSED_PAD src0_sel:DWORD src1_sel:WORD_0
    v_exp_f32 v185, v137
    v_exp_f32 v186, v138
    v_exp_f32 v187, v139
    ds_write_b16 v26, v218
    ds_write_b16_d16_hi v26, v218 offset:16
    v_mfma_f32_32x32x16_bf16 v[116:131], v[96:99], v[40:43], v[116:131]
    ds_read_b128 v[104:107], v12
    buffer_load_dwordx4 v[254:255], s[4:7], 0 idxen offen offset:2048 lds
    buffer_load_dwordx4 v[6:7], s[4:7], 0 idxen offen offset:3072 lds
    v_exp_f32 v188, v140
    v_exp_f32 v189, v141
    v_exp_f32 v190, v142
    v_exp_f32 v191, v143
    v_mfma_f32_32x32x16_bf16 v[116:131], v[100:103], v[44:47], v[116:131]
    v_exp_f32 v192, v144
    v_lshlrev_b32_sdwa v231, 3, v213 dst_sel:DWORD dst_unused:UNUSED_PAD src0_sel:DWORD src1_sel:WORD_0
    v_exp_f32 v193, v145
    v_exp_f32 v194, v146
    v_exp_f32 v195, v147
    buffer_load_dwordx2 v[214:215], v212, s[52:55], 0 idxen
    ds_read_b96 v[228:230], v231 offset:53248
    v_mfma_f32_32x32x8_bf16 v[180:195], v[248:249], v[248:249], v[180:195]
    v_cvt_pk_bf16_f32 v196, v64, v65
    v_cvt_pk_bf16_f32 v197, v66, v67
    v_cvt_pk_bf16_f32 v198, v68, v69
    v_cvt_pk_bf16_f32 v199, v70, v71
    s_waitcnt lgkmcnt(1)
    v_cndmask_b32 v104, v104, v220, s[30:31]
    v_cvt_pk_bf16_f32 v200, v72, v73
    v_cvt_pk_bf16_f32 v201, v74, v75
    v_cvt_pk_bf16_f32 v202, v76, v77
    v_cvt_pk_bf16_f32 v203, v78, v79
    v_mfma_f32_32x32x16_bf16 v[116:131], v[104:107], v[80:83], v[116:131]
    s_nop 0
    v_rcp_f32 v180, v180
    v_rcp_f32 v181, v181
    v_rcp_f32 v182, v182
    v_rcp_f32 v183, v183
    v_mfma_f32_32x32x16_bf16 v[148:163], v[196:199], v[108:111], v[148:163]
    v_rcp_f32 v184, v184
    v_rcp_f32 v185, v185
    v_rcp_f32 v186, v186
    v_rcp_f32 v187, v187
    v_mfma_f32_32x32x16_bf16 v[148:163], v[200:203], v[112:115], v[148:163]
    v_rcp_f32 v188, v188
    v_rcp_f32 v189, v189
    v_rcp_f32 v190, v190
    v_rcp_f32 v191, v191
    v_rcp_f32 v192, v192
    v_rcp_f32 v193, v193
    v_rcp_f32 v194, v194
    v_rcp_f32 v195, v195
    v_pk_mul_f32 v[64:65], v[180:181], v[132:133]
    v_pk_mul_f32 v[66:67], v[182:183], v[134:135]
    v_pk_mul_f32 v[68:69], v[184:185], v[136:137]
    v_pk_mul_f32 v[70:71], v[186:187], v[138:139]
    v_pk_mul_f32 v[72:73], v[188:189], v[140:141]
    v_pk_mul_f32 v[74:75], v[190:191], v[142:143]
    v_pk_mul_f32 v[76:77], v[192:193], v[144:145]
    v_pk_mul_f32 v[78:79], v[194:195], v[146:147]
    v_mfma_f32_32x32x16_bf16 v[132:147], v[88:91], v[48:51], 0
    v_exp_f32 v180, v116
    v_exp_f32 v181, v117
    v_exp_f32 v182, v118
    v_exp_f32 v183, v119
    v_mfma_f32_32x32x16_bf16 v[132:147], v[92:95], v[52:55], v[132:147]
    v_exp_f32 v184, v120
    v_exp_f32 v185, v121
    v_exp_f32 v186, v122
    v_exp_f32 v187, v123
    v_mfma_f32_32x32x16_bf16 v[132:147], v[96:99], v[56:59], v[132:147]
    v_exp_f32 v188, v124
    v_exp_f32 v189, v125
    v_exp_f32 v190, v126
    v_exp_f32 v191, v127
    v_mfma_f32_32x32x16_bf16 v[132:147], v[100:103], v[60:63], v[132:147]
    ds_read_b32 v250, v8 offset:0
    ds_read_b32 v252, v8 offset:64
    v_exp_f32 v192, v128
    v_exp_f32 v193, v129
    v_exp_f32 v194, v130
    v_exp_f32 v195, v131
    ds_read_b32 v254, v8 offset:128
    ds_read_b32 v6, v8 offset:192
    v_mfma_f32_32x32x8_bf16 v[180:195], v[248:249], v[248:249], v[180:195]
    v_cvt_pk_bf16_f32 v204, v64, v65
    v_cvt_pk_bf16_f32 v205, v66, v67
    v_cvt_pk_bf16_f32 v206, v68, v69
    v_cvt_pk_bf16_f32 v207, v70, v71
    v_cvt_pk_bf16_f32 v208, v72, v73
    v_cvt_pk_bf16_f32 v209, v74, v75
    v_cvt_pk_bf16_f32 v210, v76, v77
    v_cvt_pk_bf16_f32 v211, v78, v79
    v_mfma_f32_32x32x16_bf16 v[132:147], v[104:107], v[84:87], v[132:147]
    s_nop 2
    v_rcp_f32 v180, v180
    v_rcp_f32 v181, v181
    v_rcp_f32 v182, v182
    v_rcp_f32 v183, v183
    v_mfma_f32_32x32x16_bf16 v[164:179], v[204:207], v[108:111], v[164:179]
    ds_read_b64_tr_b16 v[108:109], v13 offset:0
    ds_read_b64_tr_b16 v[110:111], v13 offset:640
    v_rcp_f32 v184, v184
    v_rcp_f32 v185, v185
    v_rcp_f32 v186, v186
    v_rcp_f32 v187, v187
    s_waitcnt vmcnt(0)
    ds_read_b128 v[88:91], v2
    ds_read_b128 v[92:95], v3
    ds_read_b128 v[96:99], v4
    ds_read_b128 v[100:103], v5
    v_mfma_f32_32x32x16_bf16 v[164:179], v[208:211], v[112:115], v[164:179]
    ds_read_b64_tr_b16 v[112:113], v13 offset:1280
    ds_read_b64_tr_b16 v[114:115], v13 offset:1920
    s_add_u32 s20, s20, 1
    v_rcp_f32 v188, v188
    v_rcp_f32 v189, v189
    v_rcp_f32 v190, v190
    v_rcp_f32 v191, v191
    ds_write_b16 v26, v19
    ds_write_b16 v26, v19 offset:16
    v_rcp_f32 v192, v192
    ds_read_b128 v[196:199], v23 offset:0
    ds_read_b128 v[200:203], v23 offset:16
    ds_read_b128 v[204:207], v23 offset:32
    ds_read_b128 v[208:211], v23 offset:48
    v_rcp_f32 v193, v193
    v_rcp_f32 v194, v194
    v_rcp_f32 v195, v195
    v_pk_mul_f32 v[64:65], v[180:181], v[116:117]
    v_pk_mul_f32 v[66:67], v[182:183], v[118:119]
    v_pk_mul_f32 v[68:69], v[184:185], v[120:121]
    v_pk_mul_f32 v[70:71], v[186:187], v[122:123]
    v_pk_mul_f32 v[72:73], v[188:189], v[124:125]
    v_pk_mul_f32 v[74:75], v[190:191], v[126:127]
    v_pk_mul_f32 v[76:77], v[192:193], v[128:129]
    v_pk_mul_f32 v[78:79], v[194:195], v[130:131]
    v_cvt_pk_bf16_f32 v180, v148, v149
    v_cvt_pk_bf16_f32 v181, v150, v151
    s_lshr_b32 s28, s40, 1
    v_cvt_pk_bf16_f32 v182, v152, v153
    v_cvt_pk_bf16_f32 v183, v154, v155
    s_mul_i32 s29, s28, 136
    v_cvt_pk_bf16_f32 v184, v156, v157
    v_cvt_pk_bf16_f32 v185, v158, v159
    s_lshl_b32 s39, s28, 4
    s_waitcnt lgkmcnt(0)
    v_mfma_f32_32x32x16_bf16 v[116:131], v[196:199], v[180:183], 0
    v_cvt_pk_bf16_f32 v186, v160, v161
    s_sub_u32 s28, s78, s28
    v_cvt_pk_bf16_f32 v187, v162, v163
    s_min_u32 s28, s28, 8
    v_cvt_pk_bf16_f32 v188, v164, v165
    v_cvt_pk_bf16_f32 v189, v166, v167
    s_bfm_b32 s28, s28, 0
    v_mfma_f32_32x32x16_bf16 v[116:131], v[200:203], v[184:187], v[116:131]
    v_cvt_pk_bf16_f32 v190, v168, v169
    v_cvt_pk_bf16_f32 v191, v170, v171
    v_cvt_pk_bf16_f32 v192, v172, v173
    v_cvt_pk_bf16_f32 v193, v174, v175
    v_mfma_f32_32x32x16_bf16 v[116:131], v[204:207], v[188:191], v[116:131]
    v_cvt_pk_bf16_f32 v194, v176, v177
    v_cvt_pk_bf16_f32 v195, v178, v179
    v_add_u32 v20, s29, v16
    s_mov_b64 exec, s[56:57]
    v_add_u32 v20, s58, v16
    s_mov_b64 exec, -1
    v_add_u32 v21, s39, v17
    s_add_u32 s60, s29, 85760
    s_cmp_lg_u32 s56, 0
    s_cselect_b32 s60, s59, s60
    s_mov_b64 s[56:57], 0
    s_mul_i32 s29, s28, 0x01010100
    v_mfma_f32_32x32x16_bf16 v[116:131], v[208:211], v[192:195], v[116:131]
    v_mfma_f32_32x32x16_bf16 v[148:163], v[28:31], v[28:31], 0
    v_mfma_f32_32x32x16_bf16 v[164:179], v[28:31], v[28:31], 0
    s_mov_b32 exec_lo, s28
    s_mov_b32 exec_hi, s28
    ds_write2_b64 v20, v[180:181], v[182:183] offset0:0 offset1:2
    ds_write2_b64 v20, v[184:185], v[186:187] offset0:4 offset1:6
    ds_write2_b64 v20, v[188:189], v[190:191] offset0:8 offset1:10
    ds_write2_b64 v20, v[192:193], v[194:195] offset0:12 offset1:14
    s_mov_b64 exec, -1
    s_or_b32 s76, s29, 1
    s_mov_b32 s77, 0
    s_mov_b32 s43, 0
    s_nop 3
    v_writelane_b32 v116, s60, 0
    s_mov_b64 exec, s[76:77]
    ds_write_b32 v21, v116
    s_mov_b64 exec, -1
    s_mov_b64 s[76:77], 0
    s_branch K2_nA
    .p2align 6
K2_evlA:
    s_and_b32 s23, s23, 0x7fff
    s_cmp_ge_u32 s23, s41
    s_cbranch_scc0 K2_evs_8018
    s_mov_b32 s40, s24
    s_and_b32 s24, s21, 0xffff
    s_add_u32 s41, s24, 16
    s_mov_b32 s43, 1
    s_lshr_b32 s28, s24, 1
    v_mad_u32_u24 v20, v15, s28, v14
    v_subrev_u32 v11, s24, v10
    ds_read_b64_tr_b16 v[80:81], v20 offset:0
    ds_read_b64_tr_b16 v[82:83], v20 offset:544
    ds_read_b64_tr_b16 v[84:85], v20 offset:64
    ds_read_b64_tr_b16 v[86:87], v20 offset:608
K2_evs_8018:
    v_mfma_f32_32x32x16_bf16 v[116:131], v[92:95], v[36:39], v[116:131]
    v_exp_f32 v184, v136
    v_add_u32_sdwa v26, v11, v222 dst_sel:DWORD dst_unused:UNUSED_PAD src0_sel:DWORD src1_sel:WORD_0
    v_exp_f32 v185, v137
    v_exp_f32 v186, v138
    v_exp_f32 v187, v139
    ds_write_b16 v26, v218
    ds_write_b16_d16_hi v26, v218 offset:16
    v_mfma_f32_32x32x16_bf16 v[116:131], v[96:99], v[40:43], v[116:131]
    ds_read_b128 v[104:107], v12
    buffer_load_dwordx4 v[254:255], s[4:7], 0 idxen offen offset:2048 lds
    buffer_load_dwordx4 v[6:7], s[4:7], 0 idxen offen offset:3072 lds
    v_exp_f32 v188, v140
    v_exp_f32 v189, v141
    v_exp_f32 v190, v142
    v_exp_f32 v191, v143
    v_mfma_f32_32x32x16_bf16 v[116:131], v[100:103], v[44:47], v[116:131]
    v_exp_f32 v192, v144
    v_lshlrev_b32_sdwa v231, 3, v213 dst_sel:DWORD dst_unused:UNUSED_PAD src0_sel:DWORD src1_sel:WORD_0
    v_exp_f32 v193, v145
    v_exp_f32 v194, v146
    v_exp_f32 v195, v147
    buffer_load_dwordx2 v[214:215], v212, s[52:55], 0 idxen
    ds_read_b96 v[228:230], v231 offset:53248
    v_mfma_f32_32x32x8_bf16 v[180:195], v[248:249], v[248:249], v[180:195]
    v_cvt_pk_bf16_f32 v196, v64, v65
    v_cvt_pk_bf16_f32 v197, v66, v67
    v_cvt_pk_bf16_f32 v198, v68, v69
    v_cvt_pk_bf16_f32 v199, v70, v71
    s_waitcnt lgkmcnt(1)
    v_cndmask_b32 v104, v104, v220, s[30:31]
    v_cvt_pk_bf16_f32 v200, v72, v73
    v_cvt_pk_bf16_f32 v201, v74, v75
    v_cvt_pk_bf16_f32 v202, v76, v77
    v_cvt_pk_bf16_f32 v203, v78, v79
    v_mfma_f32_32x32x16_bf16 v[116:131], v[104:107], v[80:83], v[116:131]
    s_nop 0
    v_rcp_f32 v180, v180
    v_rcp_f32 v181, v181
    v_rcp_f32 v182, v182
    v_rcp_f32 v183, v183
    v_mfma_f32_32x32x16_bf16 v[148:163], v[196:199], v[108:111], v[148:163]
    v_rcp_f32 v184, v184
    v_rcp_f32 v185, v185
    v_rcp_f32 v186, v186
    v_rcp_f32 v187, v187
    v_mfma_f32_32x32x16_bf16 v[148:163], v[200:203], v[112:115], v[148:163]
    v_rcp_f32 v188, v188
    v_rcp_f32 v189, v189
    v_rcp_f32 v190, v190
    v_rcp_f32 v191, v191
    v_rcp_f32 v192, v192
    v_rcp_f32 v193, v193
    v_rcp_f32 v194, v194
    v_rcp_f32 v195, v195
    v_pk_mul_f32 v[64:65], v[180:181], v[132:133]
    v_pk_mul_f32 v[66:67], v[182:183], v[134:135]
    v_pk_mul_f32 v[68:69], v[184:185], v[136:137]
    v_pk_mul_f32 v[70:71], v[186:187], v[138:139]
    v_pk_mul_f32 v[72:73], v[188:189], v[140:141]
    v_pk_mul_f32 v[74:75], v[190:191], v[142:143]
    v_pk_mul_f32 v[76:77], v[192:193], v[144:145]
    v_pk_mul_f32 v[78:79], v[194:195], v[146:147]
K2_evA_C:
    v_mfma_f32_32x32x16_bf16 v[132:147], v[88:91], v[48:51], 0
    v_exp_f32 v180, v116
    v_exp_f32 v181, v117
    v_exp_f32 v182, v118
    v_exp_f32 v183, v119
    v_mfma_f32_32x32x16_bf16 v[132:147], v[92:95], v[52:55], v[132:147]
    v_exp_f32 v184, v120
    v_exp_f32 v185, v121
    v_exp_f32 v186, v122
    v_exp_f32 v187, v123
    v_mfma_f32_32x32x16_bf16 v[132:147], v[96:99], v[56:59], v[132:147]
    v_exp_f32 v188, v124
    v_exp_f32 v189, v125
    v_exp_f32 v190, v126
    v_exp_f32 v191, v127
    v_mfma_f32_32x32x16_bf16 v[132:147], v[100:103], v[60:63], v[132:147]
    ds_read_b32 v250, v8 offset:0
    ds_read_b32 v252, v8 offset:64
    v_exp_f32 v192, v128
    v_exp_f32 v193, v129
    v_exp_f32 v194, v130
    v_exp_f32 v195, v131
    ds_read_b32 v254, v8 offset:128
    ds_read_b32 v6, v8 offset:192
    v_mfma_f32_32x32x8_bf16 v[180:195], v[248:249], v[248:249], v[180:195]
    v_cvt_pk_bf16_f32 v204, v64, v65
    v_cvt_pk_bf16_f32 v205, v66, v67
    v_cvt_pk_bf16_f32 v206, v68, v69
    v_cvt_pk_bf16_f32 v207, v70, v71
    v_cvt_pk_bf16_f32 v208, v72, v73
    v_cvt_pk_bf16_f32 v209, v74, v75
    v_cvt_pk_bf16_f32 v210, v76, v77
    v_cvt_pk_bf16_f32 v211, v78, v79
    v_mfma_f32_32x32x16_bf16 v[132:147], v[104:107], v[84:87], v[132:147]
    s_nop 2
    v_rcp_f32 v180, v180
    v_rcp_f32 v181, v181
    v_rcp_f32 v182, v182
    v_rcp_f32 v183, v183
    v_mfma_f32_32x32x16_bf16 v[164:179], v[204:207], v[108:111], v[164:179]
    ds_read_b64_tr_b16 v[108:109], v13 offset:0
    ds_read_b64_tr_b16 v[110:111], v13 offset:640
    v_rcp_f32 v184, v184
    v_rcp_f32 v185, v185
    v_rcp_f32 v186, v186
    v_rcp_f32 v187, v187
    s_waitcnt vmcnt(0)
    ds_read_b128 v[88:91], v2
    ds_read_b128 v[92:95], v3
    ds_read_b128 v[96:99], v4
    ds_read_b128 v[100:103], v5
    v_mfma_f32_32x32x16_bf16 v[164:179], v[208:211], v[112:115], v[164:179]
    ds_read_b64_tr_b16 v[112:113], v13 offset:1280
    ds_read_b64_tr_b16 v[114:115], v13 offset:1920
    s_add_u32 s20, s20, 1
    v_rcp_f32 v188, v188
    v_rcp_f32 v189, v189
    v_rcp_f32 v190, v190
    v_rcp_f32 v191, v191
    ds_write_b16 v26, v19
    ds_write_b16 v26, v19 offset:16
    v_rcp_f32 v192, v192
    ds_read_b128 v[196:199], v23 offset:0
    ds_read_b128 v[200:203], v23 offset:16
    ds_read_b128 v[204:207], v23 offset:32
    ds_read_b128 v[208:211], v23 offset:48
    v_rcp_f32 v193, v193
    v_rcp_f32 v194, v194
    v_rcp_f32 v195, v195
    v_pk_mul_f32 v[64:65], v[180:181], v[116:117]
    v_pk_mul_f32 v[66:67], v[182:183], v[118:119]
    v_pk_mul_f32 v[68:69], v[184:185], v[120:121]
    v_pk_mul_f32 v[70:71], v[186:187], v[122:123]
    v_pk_mul_f32 v[72:73], v[188:189], v[124:125]
    v_pk_mul_f32 v[74:75], v[190:191], v[126:127]
    v_pk_mul_f32 v[76:77], v[192:193], v[128:129]
    v_pk_mul_f32 v[78:79], v[194:195], v[130:131]
    s_cmp_eq_u32 s43, 0
    s_cbranch_scc1 K2_evf_8019
    v_cvt_pk_bf16_f32 v180, v148, v149
    v_cvt_pk_bf16_f32 v181, v150, v151
    s_lshr_b32 s28, s40, 1
    v_cvt_pk_bf16_f32 v182, v152, v153
    v_cvt_pk_bf16_f32 v183, v154, v155
    s_mul_i32 s29, s28, 136
    v_cvt_pk_bf16_f32 v184, v156, v157
    v_cvt_pk_bf16_f32 v185, v158, v159
    s_lshl_b32 s39, s28, 4
    s_waitcnt lgkmcnt(0)
    v_mfma_f32_32x32x16_bf16 v[116:131], v[196:199], v[180:183], 0
    v_cvt_pk_bf16_f32 v186, v160, v161
    s_sub_u32 s28, s78, s28
    v_cvt_pk_bf16_f32 v187, v162, v163
    s_min_u32 s28, s28, 8
    v_cvt_pk_bf16_f32 v188, v164, v165
    v_cvt_pk_bf16_f32 v189, v166, v167
    s_bfm_b32 s28, s28, 0
    v_mfma_f32_32x32x16_bf16 v[116:131], v[200:203], v[184:187], v[116:131]
    v_cvt_pk_bf16_f32 v190, v168, v169
    v_cvt_pk_bf16_f32 v191, v170, v171
    v_cvt_pk_bf16_f32 v192, v172, v173
    v_cvt_pk_bf16_f32 v193, v174, v175
    v_mfma_f32_32x32x16_bf16 v[116:131], v[204:207], v[188:191], v[116:131]
    v_cvt_pk_bf16_f32 v194, v176, v177
    v_cvt_pk_bf16_f32 v195, v178, v179
    v_add_u32 v20, s29, v16
    s_mov_b64 exec, s[56:57]
    v_add_u32 v20, s58, v16
    s_mov_b64 exec, -1
    v_add_u32 v21, s39, v17
    s_add_u32 s60, s29, 85760
    s_cmp_lg_u32 s56, 0
    s_cselect_b32 s60, s59, s60
    s_mov_b64 s[56:57], 0
    s_mul_i32 s29, s28, 0x01010100
    v_mfma_f32_32x32x16_bf16 v[116:131], v[208:211], v[192:195], v[116:131]
    v_mfma_f32_32x32x16_bf16 v[148:163], v[28:31], v[28:31], 0
    v_mfma_f32_32x32x16_bf16 v[164:179], v[28:31], v[28:31], 0
    s_mov_b32 exec_lo, s28
    s_mov_b32 exec_hi, s28
    ds_write2_b64 v20, v[180:181], v[182:183] offset0:0 offset1:2
    ds_write2_b64 v20, v[184:185], v[186:187] offset0:4 offset1:6
    ds_write2_b64 v20, v[188:189], v[190:191] offset0:8 offset1:10
    ds_write2_b64 v20, v[192:193], v[194:195] offset0:12 offset1:14
    s_mov_b64 exec, -1
    s_or_b32 s76, s29, 1
    s_mov_b32 s77, 0
    s_mov_b32 s43, 0
    s_nop 3
    v_writelane_b32 v116, s60, 0
    s_mov_b64 exec, s[76:77]
    ds_write_b32 v21, v116
    s_mov_b64 exec, -1
    s_mov_b64 s[76:77], 0
K2_evf_8019:
    s_cmp_ge_u32 s20, s19
    s_cbranch_scc1 K2_fin
    s_branch K2_nA
K2_nt0:
    s_cmp_eq_u32 s16, 7
    s_cbranch_scc1 K2_fh_8020
    v_lshlrev_b32 v31, 4, v1
    s_mov_b32 s28, 7118848
    buffer_load_dwordx4 v[32:35], v31, s[8:11], s28 offen offset:0
    buffer_load_dwordx4 v[36:39], v31, s[8:11], s28 offen offset:1024
    buffer_load_dwordx4 v[40:43], v31, s[8:11], s28 offen offset:2048
    buffer_load_dwordx4 v[44:47], v31, s[8:11], s28 offen offset:3072
    s_mov_b32 s28, 7122944
    buffer_load_dwordx4 v[48:51], v31, s[8:11], s28 offen offset:0
    buffer_load_dwordx4 v[52:55], v31, s[8:11], s28 offen offset:1024
    buffer_load_dwordx4 v[56:59], v31, s[8:11], s28 offen offset:2048
    buffer_load_dwordx4 v[60:63], v31, s[8:11], s28 offen offset:3072
K2_fh_8020:
K2_u1:
    s_waitcnt vmcnt(0)
    v_mfma_f32_32x32x16_bf16 v[88:103], v[32:35], v[232:235], 0
    v_mfma_f32_32x32x16_bf16 v[132:147], v[48:51], v[232:235], 0
    v_mfma_f32_32x32x16_bf16 v[88:103], v[36:39], v[236:239], v[88:103]
    v_mfma_f32_32x32x16_bf16 v[132:147], v[52:55], v[236:239], v[132:147]
    v_mfma_f32_32x32x16_bf16 v[88:103], v[40:43], v[240:243], v[88:103]
    v_mfma_f32_32x32x16_bf16 v[132:147], v[56:59], v[240:243], v[132:147]
    v_mfma_f32_32x32x16_bf16 v[88:103], v[44:47], v[244:247], v[88:103]
    v_mfma_f32_32x32x16_bf16 v[132:147], v[60:63], v[244:247], v[132:147]
    s_branch K2_loopdone
K2_fin:
    s_cmp_eq_u32 s16, 7
    s_cbranch_scc1 K2_fh_8021
    v_lshlrev_b32 v31, 4, v1
    s_mov_b32 s28, 7118848
    buffer_load_dwordx4 v[32:35], v31, s[8:11], s28 offen offset:0
    buffer_load_dwordx4 v[36:39], v31, s[8:11], s28 offen offset:1024
    buffer_load_dwordx4 v[40:43], v31, s[8:11], s28 offen offset:2048
    buffer_load_dwordx4 v[44:47], v31, s[8:11], s28 offen offset:3072
    s_mov_b32 s28, 7122944
    buffer_load_dwordx4 v[48:51], v31, s[8:11], s28 offen offset:0
    buffer_load_dwordx4 v[52:55], v31, s[8:11], s28 offen offset:1024
    buffer_load_dwordx4 v[56:59], v31, s[8:11], s28 offen offset:2048
    buffer_load_dwordx4 v[60:63], v31, s[8:11], s28 offen offset:3072
K2_fh_8021:
    s_waitcnt lgkmcnt(0)
    v_exp_f32 v180, v132
    v_exp_f32 v181, v133
    v_exp_f32 v182, v134
    v_exp_f32 v183, v135
    v_exp_f32 v184, v136
    v_exp_f32 v185, v137
    v_exp_f32 v186, v138
    v_exp_f32 v187, v139
    v_exp_f32 v188, v140
    v_exp_f32 v189, v141
    v_exp_f32 v190, v142
    v_exp_f32 v191, v143
    v_exp_f32 v192, v144
    v_exp_f32 v193, v145
    v_exp_f32 v194, v146
    v_exp_f32 v195, v147
    s_nop 1
    v_mfma_f32_32x32x8_bf16 v[180:195], v[248:249], v[248:249], v[180:195]
    v_cvt_pk_bf16_f32 v196, v64, v65
    v_cvt_pk_bf16_f32 v197, v66, v67
    v_cvt_pk_bf16_f32 v198, v68, v69
    v_cvt_pk_bf16_f32 v199, v70, v71
    v_cvt_pk_bf16_f32 v200, v72, v73
    v_cvt_pk_bf16_f32 v201, v74, v75
    v_cvt_pk_bf16_f32 v202, v76, v77
    v_cvt_pk_bf16_f32 v203, v78, v79
    s_nop 3
    v_rcp_f32 v180, v180
    v_rcp_f32 v181, v181
    v_rcp_f32 v182, v182
    v_rcp_f32 v183, v183
    v_mfma_f32_32x32x16_bf16 v[148:163], v[196:199], v[108:111], v[148:163]
    v_rcp_f32 v184, v184
    v_rcp_f32 v185, v185
    v_rcp_f32 v186, v186
    v_rcp_f32 v187, v187
    v_mfma_f32_32x32x16_bf16 v[148:163], v[200:203], v[112:115], v[148:163]
    v_rcp_f32 v188, v188
    v_rcp_f32 v189, v189
    v_rcp_f32 v190, v190
    ds_read_b128 v[196:199], v23 offset:0
    ds_read_b128 v[200:203], v23 offset:16
    v_rcp_f32 v191, v191
    v_rcp_f32 v192, v192
    v_rcp_f32 v193, v193
    v_rcp_f32 v194, v194
    v_rcp_f32 v195, v195
    v_pk_mul_f32 v[64:65], v[180:181], v[132:133]
    v_pk_mul_f32 v[66:67], v[182:183], v[134:135]
    v_pk_mul_f32 v[68:69], v[184:185], v[136:137]
    v_pk_mul_f32 v[70:71], v[186:187], v[138:139]
    v_pk_mul_f32 v[72:73], v[188:189], v[140:141]
    v_pk_mul_f32 v[74:75], v[190:191], v[142:143]
    v_pk_mul_f32 v[76:77], v[192:193], v[144:145]
    v_pk_mul_f32 v[78:79], v[194:195], v[146:147]
    v_cvt_pk_bf16_f32 v204, v64, v65
    v_cvt_pk_bf16_f32 v205, v66, v67
    s_waitcnt vmcnt(0)
    v_mfma_f32_32x32x16_bf16 v[88:103], v[32:35], v[232:235], 0
    v_cvt_pk_bf16_f32 v206, v68, v69
    v_cvt_pk_bf16_f32 v207, v70, v71
    v_mfma_f32_32x32x16_bf16 v[132:147], v[48:51], v[232:235], 0
    v_cvt_pk_bf16_f32 v208, v72, v73
    v_cvt_pk_bf16_f32 v209, v74, v75
    v_mfma_f32_32x32x16_bf16 v[88:103], v[36:39], v[236:239], v[88:103]
    v_cvt_pk_bf16_f32 v210, v76, v77
    v_cvt_pk_bf16_f32 v211, v78, v79
    ds_read_b128 v[64:67], v23 offset:32
    ds_read_b128 v[68:71], v23 offset:48
    v_mfma_f32_32x32x16_bf16 v[132:147], v[52:55], v[236:239], v[132:147]
    v_mfma_f32_32x32x16_bf16 v[164:179], v[204:207], v[108:111], v[164:179]
    v_mfma_f32_32x32x16_bf16 v[164:179], v[208:211], v[112:115], v[164:179]
    s_mov_b32 s40, s24
    v_mfma_f32_32x32x16_bf16 v[88:103], v[40:43], v[240:243], v[88:103]
    v_cvt_pk_bf16_f32 v180, v148, v149
    v_cvt_pk_bf16_f32 v181, v150, v151
    s_lshr_b32 s28, s40, 1
    v_mfma_f32_32x32x16_bf16 v[132:147], v[56:59], v[240:243], v[132:147]
    v_cvt_pk_bf16_f32 v182, v152, v153
    v_cvt_pk_bf16_f32 v183, v154, v155
    s_mul_i32 s29, s28, 136
    v_cvt_pk_bf16_f32 v184, v156, v157
    v_cvt_pk_bf16_f32 v185, v158, v159
    s_lshl_b32 s39, s28, 4
    s_waitcnt lgkmcnt(0)
    v_mfma_f32_32x32x16_bf16 v[116:131], v[196:199], v[180:183], 0
    v_cvt_pk_bf16_f32 v186, v160, v161
    s_sub_u32 s28, s78, s28
    v_mfma_f32_32x32x16_bf16 v[88:103], v[44:47], v[244:247], v[88:103]
    v_cvt_pk_bf16_f32 v187, v162, v163
    s_min_u32 s28, s28, 8
    v_cvt_pk_bf16_f32 v188, v164, v165
    v_cvt_pk_bf16_f32 v189, v166, v167
    s_bfm_b32 s28, s28, 0
    v_mfma_f32_32x32x16_bf16 v[116:131], v[200:203], v[184:187], v[116:131]
    v_cvt_pk_bf16_f32 v190, v168, v169
    v_mfma_f32_32x32x16_bf16 v[132:147], v[60:63], v[244:247], v[132:147]
    v_cvt_pk_bf16_f32 v191, v170, v171
    v_cvt_pk_bf16_f32 v192, v172, v173
    v_cvt_pk_bf16_f32 v193, v174, v175
    v_mfma_f32_32x32x16_bf16 v[116:131], v[64:67], v[188:191], v[116:131]
    v_cvt_pk_bf16_f32 v194, v176, v177
    v_cvt_pk_bf16_f32 v195, v178, v179
    v_add_u32 v20, s29, v16
    s_mov_b64 exec, s[56:57]
    v_add_u32 v20, s58, v16
    s_mov_b64 exec, -1
    v_add_u32 v21, s39, v17
    s_add_u32 s60, s29, 85760
    s_cmp_lg_u32 s56, 0
    s_cselect_b32 s60, s59, s60
    s_mov_b64 s[56:57], 0
    s_mul_i32 s29, s28, 0x01010100
    v_mfma_f32_32x32x16_bf16 v[116:131], v[68:71], v[192:195], v[116:131]
    s_mov_b32 exec_lo, s28
    s_mov_b32 exec_hi, s28
    ds_write2_b64 v20, v[180:181], v[182:183] offset0:0 offset1:2
    ds_write2_b64 v20, v[184:185], v[186:187] offset0:4 offset1:6
    ds_write2_b64 v20, v[188:189], v[190:191] offset0:8 offset1:10
    ds_write2_b64 v20, v[192:193], v[194:195] offset0:12 offset1:14
    s_mov_b64 exec, -1
    s_or_b32 s76, s29, 1
    s_mov_b32 s77, 0
    s_mov_b32 s43, 0
    s_nop 3
    v_writelane_b32 v116, s60, 0
    s_mov_b64 exec, s[76:77]
    ds_write_b32 v21, v116
    s_mov_b64 exec, -1
    s_mov_b64 s[76:77], 0
K2_loopdone:
    v_lshlrev_b32 v31, 4, v1
    v_and_b32 v28, 31, v1
    v_lshrrev_b32 v29, 5, v1
    s_cmp_eq_u32 s16, 7
    s_cbranch_scc1 K2_w7bar
    v_add_u32 v30, 151584, v31
    ds_read_b128 v[148:151], v30 offset:0
    ds_read_b128 v[152:155], v30 offset:1024
    ds_read_b128 v[156:159], v30 offset:2048
    ds_read_b128 v[160:163], v30 offset:3072
    ds_read_b128 v[164:167], v30 offset:4096
    ds_read_b128 v[168:171], v30 offset:5120
    ds_read_b128 v[172:175], v30 offset:6144
    ds_read_b128 v[176:179], v30 offset:7168
    s_lshl_b32 s28, s16, 5
    v_add_u32 v23, s28, v28
    v_lshlrev_b32 v24, 4, v23
    v_add_u32 v24, 148320, v24
    v_mul_u32_u24 v22, 136, v23
    v_lshl_add_u32 v22, v29, 4, v22
    v_add_u32 v25, 117312, v22
    v_lshlrev_b32 v27, 4, v29
    v_add_u32 v27, 144512, v27
    s_mul_i32 s39, s16, 4608
    v_mul_u32_u24 v22, 144, v28
    v_lshl_add_u32 v22, v29, 3, v22
    v_add_u32 v22, s39, v22
    v_lshrrev_b32 v21, 3, v1
    v_mul_u32_u24 v20, 144, v21
    v_and_b32 v26, 7, v1
    v_lshl_add_u32 v20, v26, 4, v20
    v_add_u32 v20, s39, v20
    s_lshl_b32 s39, s16, 5
    v_add_u32 v21, s39, v21
    v_add_u32 v23, s38, v21
    v_lshlrev_b32 v23, 7, v23
    v_lshl_add_u32 v23, v26, 4, v23
    s_mov_b32 s28, 3207688728
    s_mov_b32 s29, 3207688728
    v_mov_b32 v248, 0x3f003f00
    v_mov_b32 v249, 0
    s_waitcnt lgkmcnt(0)
    s_barrier
    ds_read_b32 v24, v24
    ds_read2_b64 v[196:199], v25 offset0:0 offset1:1
    ds_read2_b64 v[200:203], v25 offset0:4 offset1:5
    ds_read2_b64 v[204:207], v25 offset0:8 offset1:9
    ds_read2_b64 v[208:211], v25 offset0:12 offset1:13
    s_waitcnt lgkmcnt(4)
    v_cmp_ne_u32 vcc, -1, v24
    v_lshl_add_u32 v26, v29, 4, v24
    s_nop 0
    v_cndmask_b32 v26, v27, v26, vcc
    ds_read2_b64 v[64:67], v26 offset0:0 offset1:1
    ds_read2_b64 v[68:71], v26 offset0:4 offset1:5
    ds_read2_b64 v[72:75], v26 offset0:8 offset1:9
    ds_read2_b64 v[76:79], v26 offset0:12 offset1:13
    s_waitcnt lgkmcnt(7)
    v_mfma_f32_32x32x16_bf16 v[88:103], v[148:151], v[196:199], v[88:103]
    s_waitcnt lgkmcnt(6)
    v_mfma_f32_32x32x16_bf16 v[88:103], v[152:155], v[200:203], v[88:103]
    s_waitcnt lgkmcnt(5)
    v_mfma_f32_32x32x16_bf16 v[88:103], v[156:159], v[204:207], v[88:103]
    s_waitcnt lgkmcnt(4)
    v_mfma_f32_32x32x16_bf16 v[88:103], v[160:163], v[208:211], v[88:103]
    s_waitcnt lgkmcnt(3)
    v_mfma_f32_32x32x16_bf16 v[88:103], v[148:151], v[64:67], v[88:103]
    s_waitcnt lgkmcnt(2)
    v_mfma_f32_32x32x16_bf16 v[88:103], v[152:155], v[68:71], v[88:103]
    s_waitcnt lgkmcnt(1)
    v_mfma_f32_32x32x16_bf16 v[88:103], v[156:159], v[72:75], v[88:103]
    s_waitcnt lgkmcnt(0)
    v_mfma_f32_32x32x16_bf16 v[88:103], v[160:163], v[76:79], v[88:103]
    v_mfma_f32_32x32x16_bf16 v[132:147], v[164:167], v[196:199], v[132:147]
    v_lshlrev_b32 v212, 16, v232
    v_and_b32 v213, 0xffff0000, v232
    v_lshlrev_b32 v214, 16, v233
    v_and_b32 v215, 0xffff0000, v233
    v_lshlrev_b32 v216, 16, v234
    v_and_b32 v217, 0xffff0000, v234
    v_lshlrev_b32 v218, 16, v235
    v_and_b32 v219, 0xffff0000, v235
    v_lshlrev_b32 v220, 16, v236
    v_and_b32 v221, 0xffff0000, v236
    v_lshlrev_b32 v222, 16, v237
    v_and_b32 v223, 0xffff0000, v237
    v_lshlrev_b32 v224, 16, v238
    v_and_b32 v225, 0xffff0000, v238
    v_lshlrev_b32 v226, 16, v239
    v_and_b32 v227, 0xffff0000, v239
    v_mfma_f32_32x32x16_bf16 v[132:147], v[168:171], v[200:203], v[132:147]
    v_exp_f32 v32, v88
    v_exp_f32 v33, v89
    v_mfma_f32_32x32x16_bf16 v[132:147], v[172:175], v[204:207], v[132:147]
    v_exp_f32 v34, v90
    v_exp_f32 v35, v91
    v_exp_f32 v36, v92
    v_exp_f32 v37, v93
    v_mfma_f32_32x32x16_bf16 v[132:147], v[176:179], v[208:211], v[132:147]
    v_exp_f32 v38, v94
    v_exp_f32 v39, v95
    v_exp_f32 v40, v96
    v_exp_f32 v41, v97
    v_mfma_f32_32x32x16_bf16 v[132:147], v[164:167], v[64:67], v[132:147]
    v_exp_f32 v42, v98
    v_exp_f32 v43, v99
    v_exp_f32 v44, v100
    v_exp_f32 v45, v101
    v_exp_f32 v46, v102
    v_exp_f32 v47, v103
    s_nop 1
    v_mfma_f32_32x32x8_bf16 v[32:47], v[248:249], v[248:249], v[32:47]
    v_lshlrev_b32 v116, 16, v240
    v_and_b32 v117, 0xffff0000, v240
    v_lshlrev_b32 v118, 16, v241
    v_and_b32 v119, 0xffff0000, v241
    v_lshlrev_b32 v120, 16, v242
    v_and_b32 v121, 0xffff0000, v242
    v_lshlrev_b32 v122, 16, v243
    v_and_b32 v123, 0xffff0000, v243
    v_lshlrev_b32 v124, 16, v244
    v_and_b32 v125, 0xffff0000, v244
    v_lshlrev_b32 v126, 16, v245
    v_and_b32 v127, 0xffff0000, v245
    v_lshlrev_b32 v128, 16, v246
    v_and_b32 v129, 0xffff0000, v246
    v_lshlrev_b32 v130, 16, v247
    v_and_b32 v131, 0xffff0000, v247
    v_mfma_f32_32x32x16_bf16 v[132:147], v[168:171], v[68:71], v[132:147]
    v_rcp_f32 v32, v32
    v_rcp_f32 v33, v33
    v_rcp_f32 v34, v34
    v_rcp_f32 v35, v35
    v_mfma_f32_32x32x16_bf16 v[132:147], v[172:175], v[72:75], v[132:147]
    v_rcp_f32 v36, v36
    v_rcp_f32 v37, v37
    v_rcp_f32 v38, v38
    v_rcp_f32 v39, v39
    v_mfma_f32_32x32x16_bf16 v[132:147], v[176:179], v[76:79], v[132:147]
    v_rcp_f32 v40, v40
    v_rcp_f32 v41, v41
    v_rcp_f32 v42, v42
    v_rcp_f32 v43, v43
    v_rcp_f32 v44, v44
    v_rcp_f32 v45, v45
    v_rcp_f32 v46, v46
    v_rcp_f32 v47, v47
    v_pk_mul_f32 v[32:33], v[32:33], v[88:89]
    v_pk_mul_f32 v[34:35], v[34:35], v[90:91]
    v_pk_mul_f32 v[36:37], v[36:37], v[92:93]
    v_pk_mul_f32 v[38:39], v[38:39], v[94:95]
    v_pk_mul_f32 v[40:41], v[40:41], v[96:97]
    v_pk_mul_f32 v[42:43], v[42:43], v[98:99]
    v_pk_mul_f32 v[44:45], v[44:45], v[100:101]
    v_pk_mul_f32 v[46:47], v[46:47], v[102:103]
    v_pk_fma_f32 v[32:33], v[32:33], s[28:29], v[212:213]
    v_pk_fma_f32 v[34:35], v[34:35], s[28:29], v[214:215]
    v_pk_fma_f32 v[36:37], v[36:37], s[28:29], v[216:217]
    v_pk_fma_f32 v[38:39], v[38:39], s[28:29], v[218:219]
    v_pk_fma_f32 v[40:41], v[40:41], s[28:29], v[220:221]
    v_pk_fma_f32 v[42:43], v[42:43], s[28:29], v[222:223]
    v_pk_fma_f32 v[44:45], v[44:45], s[28:29], v[224:225]
    v_pk_fma_f32 v[46:47], v[46:47], s[28:29], v[226:227]
    v_cvt_pk_bf16_f32 v180, v32, v33
    v_cvt_pk_bf16_f32 v181, v34, v35
    v_cvt_pk_bf16_f32 v182, v36, v37
    v_cvt_pk_bf16_f32 v183, v38, v39
    v_cvt_pk_bf16_f32 v184, v40, v41
    v_cvt_pk_bf16_f32 v185, v42, v43
    v_cvt_pk_bf16_f32 v186, v44, v45
    v_cvt_pk_bf16_f32 v187, v46, v47
    v_exp_f32 v48, v132
    v_exp_f32 v49, v133
    v_exp_f32 v50, v134
    v_exp_f32 v51, v135
    v_exp_f32 v52, v136
    v_exp_f32 v53, v137
    v_exp_f32 v54, v138
    v_exp_f32 v55, v139
    v_exp_f32 v56, v140
    v_exp_f32 v57, v141
    v_exp_f32 v58, v142
    v_exp_f32 v59, v143
    v_exp_f32 v60, v144
    v_exp_f32 v61, v145
    v_exp_f32 v62, v146
    v_exp_f32 v63, v147
    s_nop 1
    v_mfma_f32_32x32x8_bf16 v[48:63], v[248:249], v[248:249], v[48:63]
    ds_write2_b64 v22, v[180:181], v[182:183] offset0:0 offset1:2
    ds_write2_b64 v22, v[184:185], v[186:187] offset0:4 offset1:6
    s_nop 7
    s_nop 1
    v_rcp_f32 v48, v48
    v_rcp_f32 v49, v49
    v_rcp_f32 v50, v50
    v_rcp_f32 v51, v51
    v_rcp_f32 v52, v52
    v_rcp_f32 v53, v53
    v_rcp_f32 v54, v54
    v_rcp_f32 v55, v55
    v_rcp_f32 v56, v56
    v_rcp_f32 v57, v57
    v_rcp_f32 v58, v58
    v_rcp_f32 v59, v59
    v_rcp_f32 v60, v60
    v_rcp_f32 v61, v61
    v_rcp_f32 v62, v62
    v_rcp_f32 v63, v63
    v_pk_mul_f32 v[48:49], v[48:49], v[132:133]
    v_pk_mul_f32 v[50:51], v[50:51], v[134:135]
    v_pk_mul_f32 v[52:53], v[52:53], v[136:137]
    v_pk_mul_f32 v[54:55], v[54:55], v[138:139]
    v_pk_mul_f32 v[56:57], v[56:57], v[140:141]
    v_pk_mul_f32 v[58:59], v[58:59], v[142:143]
    v_pk_mul_f32 v[60:61], v[60:61], v[144:145]
    v_pk_mul_f32 v[62:63], v[62:63], v[146:147]
    v_pk_fma_f32 v[48:49], v[48:49], s[28:29], v[116:117]
    v_pk_fma_f32 v[50:51], v[50:51], s[28:29], v[118:119]
    v_pk_fma_f32 v[52:53], v[52:53], s[28:29], v[120:121]
    v_pk_fma_f32 v[54:55], v[54:55], s[28:29], v[122:123]
    v_pk_fma_f32 v[56:57], v[56:57], s[28:29], v[124:125]
    v_pk_fma_f32 v[58:59], v[58:59], s[28:29], v[126:127]
    v_pk_fma_f32 v[60:61], v[60:61], s[28:29], v[128:129]
    v_pk_fma_f32 v[62:63], v[62:63], s[28:29], v[130:131]
    v_cvt_pk_bf16_f32 v188, v48, v49
    v_cvt_pk_bf16_f32 v189, v50, v51
    v_cvt_pk_bf16_f32 v190, v52, v53
    v_cvt_pk_bf16_f32 v191, v54, v55
    v_cvt_pk_bf16_f32 v192, v56, v57
    v_cvt_pk_bf16_f32 v193, v58, v59
    v_cvt_pk_bf16_f32 v194, v60, v61
    v_cvt_pk_bf16_f32 v195, v62, v63
    ds_write2_b64 v22, v[188:189], v[190:191] offset0:8 offset1:10
    ds_write2_b64 v22, v[192:193], v[194:195] offset0:12 offset1:14
    s_waitcnt lgkmcnt(0)
    ds_read_b128 v[88:91], v20 offset:0
    ds_read_b128 v[92:95], v20 offset:1152
    ds_read_b128 v[96:99], v20 offset:2304
    ds_read_b128 v[100:103], v20 offset:3456
    v_add_u32 v27, 0, v21
    v_cmp_gt_u32 vcc, s37, v27
    s_waitcnt lgkmcnt(3)
    s_mov_b64 exec, vcc
    buffer_store_dwordx4 v[88:91], v23, s[12:15], 0 offen offset:0 sc1 nt
    s_mov_b64 exec, -1
    v_add_u32 v27, 8, v21
    v_cmp_gt_u32 vcc, s37, v27
    s_waitcnt lgkmcnt(2)
    s_mov_b64 exec, vcc
    buffer_store_dwordx4 v[92:95], v23, s[12:15], 0 offen offset:1024 sc1 nt
    s_mov_b64 exec, -1
    v_add_u32 v27, 16, v21
    v_cmp_gt_u32 vcc, s37, v27
    s_waitcnt lgkmcnt(1)
    s_mov_b64 exec, vcc
    buffer_store_dwordx4 v[96:99], v23, s[12:15], 0 offen offset:2048 sc1 nt
    s_mov_b64 exec, -1
    v_add_u32 v27, 24, v21
    v_cmp_gt_u32 vcc, s37, v27
    s_waitcnt lgkmcnt(0)
    s_mov_b64 exec, vcc
    buffer_store_dwordx4 v[100:103], v23, s[12:15], 0 offen offset:3072 sc1 nt
    s_mov_b64 exec, -1
    s_branch K2_done
K2_w7bar:
    s_waitcnt vmcnt(0) lgkmcnt(0)
    s_barrier
    s_mov_b32 s28, 3207688728
    v_add_u32 v22, 0, v1
    v_cmp_gt_u32 vcc, s37, v22
    s_and_saveexec_b64 s[34:35], vcc
    s_cbranch_execz K2_po_8022
    v_lshlrev_b32 v23, 4, v22
    v_add_u32 v24, 148320, v23
    v_add_u32 v23, 145056, v23
    ds_read_b128 v[32:35], v23
    ds_read_b128 v[40:43], v24
    v_lshlrev_b32 v23, 4, v22
    ds_read_b96 v[28:30], v23 offset:53248
    s_waitcnt lgkmcnt(0)
    v_add_f32 v33, v33, v41
    v_add_f32 v34, v34, v42
    v_add_f32 v35, v35, v43
    v_mov_b32 v27, v30
    v_mov_b32 v31, v29
    v_mov_b32 v30, v28
    v_fma_f32 v30, v33, s28, v30
    v_fma_f32 v31, v34, s28, v31
    v_fma_f32 v27, v35, s28, v27
    v_cvt_pk_bf16_f32 v30, v30, v31
    v_cvt_pk_bf16_f32 v27, v27, v27
    v_mul_u32_u24 v22, 6, v22
    ds_write_b16 v22, v30 offset:50688
    ds_write_b16_d16_hi v22, v30 offset:50690
    ds_write_b16 v22, v27 offset:50692
K2_po_8022:
    s_mov_b64 exec, s[34:35]
    v_add_u32 v22, 64, v1
    v_cmp_gt_u32 vcc, s37, v22
    s_and_saveexec_b64 s[34:35], vcc
    s_cbranch_execz K2_po_8023
    v_lshlrev_b32 v23, 4, v22
    v_add_u32 v24, 148320, v23
    v_add_u32 v23, 145056, v23
    ds_read_b128 v[32:35], v23
    ds_read_b128 v[40:43], v24
    v_lshlrev_b32 v23, 4, v22
    ds_read_b96 v[28:30], v23 offset:53248
    s_waitcnt lgkmcnt(0)
    v_add_f32 v33, v33, v41
    v_add_f32 v34, v34, v42
    v_add_f32 v35, v35, v43
    v_mov_b32 v27, v30
    v_mov_b32 v31, v29
    v_mov_b32 v30, v28
    v_fma_f32 v30, v33, s28, v30
    v_fma_f32 v31, v34, s28, v31
    v_fma_f32 v27, v35, s28, v27
    v_cvt_pk_bf16_f32 v30, v30, v31
    v_cvt_pk_bf16_f32 v27, v27, v27
    v_mul_u32_u24 v22, 6, v22
    ds_write_b16 v22, v30 offset:50688
    ds_write_b16_d16_hi v22, v30 offset:50690
    ds_write_b16 v22, v27 offset:50692
K2_po_8023:
    s_mov_b64 exec, s[34:35]
    v_add_u32 v22, 128, v1
    v_cmp_gt_u32 vcc, s37, v22
    s_and_saveexec_b64 s[34:35], vcc
    s_cbranch_execz K2_po_8024
    v_lshlrev_b32 v23, 4, v22
    v_add_u32 v24, 148320, v23
    v_add_u32 v23, 145056, v23
    ds_read_b128 v[32:35], v23
    ds_read_b128 v[40:43], v24
    v_lshlrev_b32 v23, 4, v22
    ds_read_b96 v[28:30], v23 offset:53248
    s_waitcnt lgkmcnt(0)
    v_add_f32 v33, v33, v41
    v_add_f32 v34, v34, v42
    v_add_f32 v35, v35, v43
    v_mov_b32 v27, v30
    v_mov_b32 v31, v29
    v_mov_b32 v30, v28
    v_fma_f32 v30, v33, s28, v30
    v_fma_f32 v31, v34, s28, v31
    v_fma_f32 v27, v35, s28, v27
    v_cvt_pk_bf16_f32 v30, v30, v31
    v_cvt_pk_bf16_f32 v27, v27, v27
    v_mul_u32_u24 v22, 6, v22
    ds_write_b16 v22, v30 offset:50688
    ds_write_b16_d16_hi v22, v30 offset:50690
    ds_write_b16 v22, v27 offset:50692
K2_po_8024:
    s_mov_b64 exec, s[34:35]
    v_add_u32 v22, 192, v1
    v_cmp_gt_u32 vcc, s37, v22
    s_and_saveexec_b64 s[34:35], vcc
    s_cbranch_execz K2_po_8025
    v_lshlrev_b32 v23, 4, v22
    v_add_u32 v24, 148320, v23
    v_add_u32 v23, 145056, v23
    ds_read_b128 v[32:35], v23
    ds_read_b128 v[40:43], v24
    v_lshlrev_b32 v23, 4, v22
    ds_read_b96 v[28:30], v23 offset:53248
    s_waitcnt lgkmcnt(0)
    v_add_f32 v33, v33, v41
    v_add_f32 v34, v34, v42
    v_add_f32 v35, v35, v43
    v_mov_b32 v27, v30
    v_mov_b32 v31, v29
    v_mov_b32 v30, v28
    v_fma_f32 v30, v33, s28, v30
    v_fma_f32 v31, v34, s28, v31
    v_fma_f32 v27, v35, s28, v27
    v_cvt_pk_bf16_f32 v30, v30, v31
    v_cvt_pk_bf16_f32 v27, v27, v27
    v_mul_u32_u24 v22, 6, v22
    ds_write_b16 v22, v30 offset:50688
    ds_write_b16_d16_hi v22, v30 offset:50690
    ds_write_b16 v22, v27 offset:50692
K2_po_8025:
    s_mov_b64 exec, s[34:35]
    v_lshlrev_b32 v22, 3, v1
    ds_read_b64 v[32:33], v22 offset:50688
    ds_read_b64 v[34:35], v22 offset:51200
    ds_read_b64 v[36:37], v22 offset:51712
    s_mul_i32 s28, s38, 6
    s_add_u32 s28, s28, 6400000
    v_add_u32 v23, s28, v22
    s_mul_i32 s29, s37, 6
    v_add_u32 v24, 0, v22
    v_cmp_gt_u32 vcc, s29, v24
    s_waitcnt lgkmcnt(2)
    s_mov_b64 exec, vcc
    buffer_store_dwordx2 v[32:33], v23, s[12:15], 0 offen offset:0 sc1 nt
    s_mov_b64 exec, -1
    v_add_u32 v24, 512, v22
    v_cmp_gt_u32 vcc, s29, v24
    s_waitcnt lgkmcnt(1)
    s_mov_b64 exec, vcc
    buffer_store_dwordx2 v[34:35], v23, s[12:15], 0 offen offset:512 sc1 nt
    s_mov_b64 exec, -1
    v_add_u32 v24, 1024, v22
    v_cmp_gt_u32 vcc, s29, v24
    s_waitcnt lgkmcnt(0)
    s_mov_b64 exec, vcc
    buffer_store_dwordx2 v[36:37], v23, s[12:15], 0 offen offset:1024 sc1 nt
    s_mov_b64 exec, -1
K2_done:
    s_endpgm
    .p2align 6
K2_rare_1o:
    s_mov_b32 s18, 1
    v_add_u32 v186, 8, v226
    v_add_u32 v187, 9, v226
    v_lshlrev_b32_sdwa v22, 3, v184 dst_sel:DWORD dst_unused:UNUSED_PAD src0_sel:DWORD src1_sel:WORD_0
    v_add_u32 v22, v22, v26
    s_mov_b32 s29, 0
    v_cmp_gt_u32_sdwa s[64:65], v184, v186 src0_sel:WORD_1 src1_sel:DWORD
    v_cmp_gt_u32_sdwa s[66:67], v184, v187 src0_sel:WORD_1 src1_sel:DWORD
    s_mov_b64 exec, s[64:65]
    buffer_load_dwordx4 v[140:143], v22, s[8:11], s29 offen offset:192
    s_mov_b64 exec, -1
    v_lshlrev_b32_sdwa v22, 3, v185 dst_sel:DWORD dst_unused:UNUSED_PAD src0_sel:DWORD src1_sel:WORD_0
    v_add_u32 v22, v22, v26
    s_mov_b32 s29, 436224
    v_cmp_gt_u32_sdwa s[68:69], v185, v186 src0_sel:WORD_1 src1_sel:DWORD
    v_cmp_gt_u32_sdwa s[70:71], v185, v187 src0_sel:WORD_1 src1_sel:DWORD
    s_mov_b64 exec, s[68:69]
    buffer_load_dwordx4 v[144:147], v22, s[8:11], s29 offen offset:192
    s_mov_b64 exec, -1
    s_mov_b32 s28, 2162688
    v_cmp_le_u32 vcc, s28, v27
    s_cbranch_vccz K2_no3
    s_mov_b32 s99, 1
    s_mov_b32 s28, 3211264
    v_cmp_le_u32 vcc, s28, v27
    s_cbranch_vccz K2_nobad
    s_mov_b32 s99, 2
K2_nobad:
    v_lshlrev_b32_sdwa v22, 3, v180 dst_sel:DWORD dst_unused:UNUSED_PAD src0_sel:DWORD src1_sel:WORD_0
    v_add_u32 v22, v22, v24
    s_mov_b32 s29, 0
    v_cmp_gt_u32_sdwa vcc, v180, v228 src0_sel:WORD_1 src1_sel:DWORD
    s_mov_b64 exec, vcc
    buffer_load_dwordx4 v[80:83], v22, s[8:11], s29 offen offset:256
    s_mov_b64 exec, -1
    v_lshlrev_b32_sdwa v22, 3, v181 dst_sel:DWORD dst_unused:UNUSED_PAD src0_sel:DWORD src1_sel:WORD_0
    v_add_u32 v22, v22, v24
    s_mov_b32 s29, 218112
    v_cmp_gt_u32_sdwa vcc, v181, v228 src0_sel:WORD_1 src1_sel:DWORD
    s_mov_b64 exec, vcc
    buffer_load_dwordx4 v[84:87], v22, s[8:11], s29 offen offset:256
    s_mov_b64 exec, -1
    v_lshlrev_b32_sdwa v22, 3, v182 dst_sel:DWORD dst_unused:UNUSED_PAD src0_sel:DWORD src1_sel:WORD_0
    v_add_u32 v22, v22, v24
    s_mov_b32 s29, 436224
    v_cmp_gt_u32_sdwa vcc, v182, v228 src0_sel:WORD_1 src1_sel:DWORD
    s_mov_b64 exec, vcc
    buffer_load_dwordx4 v[104:107], v22, s[8:11], s29 offen offset:256
    s_mov_b64 exec, -1
    v_lshlrev_b32_sdwa v22, 3, v183 dst_sel:DWORD dst_unused:UNUSED_PAD src0_sel:DWORD src1_sel:WORD_0
    v_add_u32 v22, v22, v24
    s_mov_b32 s29, 654336
    v_cmp_gt_u32_sdwa vcc, v183, v228 src0_sel:WORD_1 src1_sel:DWORD
    s_mov_b64 exec, vcc
    buffer_load_dwordx4 v[108:111], v22, s[8:11], s29 offen offset:256
    s_mov_b64 exec, -1
K2_no3:
    s_branch K2_rare_1
    .p2align 6
K2_wa0:
    s_waitcnt vmcnt(10) lgkmcnt(0)
    s_branch K2_wa1
    .p2align 6
K2_rare_2o:
    s_sub_u32 s78, s78, 1
    s_cbranch_scc1 K2_chkx
    v_mov_b32 v116, s24
    v_mov_b32 v117, s25
    v_mov_b32 v118, s26
    v_mov_b32 v119, s17
    v_mov_b32 v120, s24
    v_mov_b32 v121, s25
    v_mov_b32 v122, s26
    v_mov_b32 v123, s17
    v_mov_b32 v124, s24
    v_mov_b32 v125, s25
    v_mov_b32 v126, s26
    v_mov_b32 v127, s17
    v_mov_b32 v128, s24
    v_mov_b32 v129, s25
    v_mov_b32 v130, s26
    v_mov_b32 v131, s17
    v_mov_b32 v132, s24
    v_mov_b32 v133, s25
    v_mov_b32 v134, s26
    v_mov_b32 v135, s17
    v_mov_b32 v136, s24
    v_mov_b32 v137, s25
    v_mov_b32 v138, s26
    v_mov_b32 v139, s17
    s_mov_b64 exec, s[40:41]
    v_lshlrev_b32_sdwa v22, 3, v180 dst_sel:DWORD dst_unused:UNUSED_PAD src0_sel:DWORD src1_sel:WORD_0
    v_add_u32 v22, v22, v24
    s_mov_b32 s29, 0
    buffer_load_dwordx4 v[116:119], v22, s[8:11], s29 offen sc1
    s_mov_b64 exec, s[44:45]
    v_lshlrev_b32_sdwa v22, 3, v181 dst_sel:DWORD dst_unused:UNUSED_PAD src0_sel:DWORD src1_sel:WORD_0
    v_add_u32 v22, v22, v24
    s_mov_b32 s29, 218112
    buffer_load_dwordx4 v[120:123], v22, s[8:11], s29 offen sc1
    s_mov_b64 exec, s[48:49]
    v_lshlrev_b32_sdwa v22, 3, v182 dst_sel:DWORD dst_unused:UNUSED_PAD src0_sel:DWORD src1_sel:WORD_0
    v_add_u32 v22, v22, v24
    s_mov_b32 s29, 436224
    buffer_load_dwordx4 v[124:127], v22, s[8:11], s29 offen sc1
    s_mov_b64 exec, s[52:53]
    v_lshlrev_b32_sdwa v22, 3, v183 dst_sel:DWORD dst_unused:UNUSED_PAD src0_sel:DWORD src1_sel:WORD_0
    v_add_u32 v22, v22, v24
    s_mov_b32 s29, 654336
    buffer_load_dwordx4 v[128:131], v22, s[8:11], s29 offen sc1
    s_mov_b64 exec, s[56:57]
    v_lshlrev_b32_sdwa v22, 3, v184 dst_sel:DWORD dst_unused:UNUSED_PAD src0_sel:DWORD src1_sel:WORD_0
    v_add_u32 v22, v22, v26
    s_mov_b32 s29, 0
    buffer_load_dwordx4 v[132:135], v22, s[8:11], s29 offen offset:128 sc1
    s_mov_b64 exec, s[60:61]
    v_lshlrev_b32_sdwa v22, 3, v185 dst_sel:DWORD dst_unused:UNUSED_PAD src0_sel:DWORD src1_sel:WORD_0
    v_add_u32 v22, v22, v26
    s_mov_b32 s29, 436224
    buffer_load_dwordx4 v[136:139], v22, s[8:11], s29 offen offset:128 sc1
    s_mov_b64 exec, -1
    s_waitcnt vmcnt(0)
    s_branch K2_chk
    s_branch K2_rare_2
    .p2align 6
K2_rare_3o:
    s_waitcnt vmcnt(11)
    v_xor_b32 v140, s24, v140
    v_xor_b32 v141, s25, v141
    v_xor_b32 v142, s26, v142
    v_xor_b32 v143, s17, v143
    s_mov_b32 s78, 200000
K2_qf_8026l:
    v_or_b32 v189, v140, v142
    v_or_b32 v190, v141, v143
    v_bfi_b32 v189, v188, v190, v189
    v_cmp_lt_u32 vcc, 0x1ff, v189
    s_and_b64 vcc, vcc, s[64:65]
    s_cbranch_scc0 K2_qf_8026d
    s_sub_u32 s78, s78, 1
    s_cbranch_scc1 K2_qf_8026d
    s_mov_b64 exec, vcc
    v_lshlrev_b32_sdwa v22, 3, v184 dst_sel:DWORD dst_unused:UNUSED_PAD src0_sel:DWORD src1_sel:WORD_0
    v_add_u32 v22, v22, v26
    s_mov_b32 s29, 0
    buffer_load_dwordx4 v[140:143], v22, s[8:11], s29 offen offset:192 sc1
    s_waitcnt vmcnt(0)
    v_xor_b32 v140, s24, v140
    v_xor_b32 v141, s25, v141
    v_xor_b32 v142, s26, v142
    v_xor_b32 v143, s17, v143
    s_mov_b64 exec, -1
    s_branch K2_qf_8026l
K2_qf_8026d:
    v_xor_b32 v144, s24, v144
    v_xor_b32 v145, s25, v145
    v_xor_b32 v146, s26, v146
    v_xor_b32 v147, s17, v147
    s_mov_b32 s78, 200000
K2_qf_8027l:
    v_or_b32 v189, v144, v146
    v_or_b32 v190, v145, v147
    v_bfi_b32 v189, v188, v190, v189
    v_cmp_lt_u32 vcc, 0x1ff, v189
    s_and_b64 vcc, vcc, s[68:69]
    s_cbranch_scc0 K2_qf_8027d
    s_sub_u32 s78, s78, 1
    s_cbranch_scc1 K2_qf_8027d
    s_mov_b64 exec, vcc
    v_lshlrev_b32_sdwa v22, 3, v185 dst_sel:DWORD dst_unused:UNUSED_PAD src0_sel:DWORD src1_sel:WORD_0
    v_add_u32 v22, v22, v26
    s_mov_b32 s29, 436224
    buffer_load_dwordx4 v[144:147], v22, s[8:11], s29 offen offset:192 sc1
    s_waitcnt vmcnt(0)
    v_xor_b32 v144, s24, v144
    v_xor_b32 v145, s25, v145
    v_xor_b32 v146, s26, v146
    v_xor_b32 v147, s17, v147
    s_mov_b64 exec, -1
    s_branch K2_qf_8027l
K2_qf_8027d:
    s_cmp_eq_u32 s99, 0
    s_cbranch_scc1 K2_fx3_8028
    v_xor_b32 v80, s24, v80
    v_xor_b32 v81, s25, v81
    v_xor_b32 v82, s26, v82
    v_xor_b32 v83, s17, v83
    v_cmp_gt_u32_sdwa s[76:77], v180, v228 src0_sel:WORD_1 src1_sel:DWORD
    s_mov_b32 s78, 200000
K2_qf_8029l:
    v_or_b32 v189, v80, v82
    v_or_b32 v190, v81, v83
    v_bfi_b32 v189, v188, v190, v189
    v_cmp_lt_u32 vcc, 0x1ff, v189
    s_and_b64 vcc, vcc, s[76:77]
    s_cbranch_scc0 K2_qf_8029d
    s_sub_u32 s78, s78, 1
    s_cbranch_scc1 K2_qf_8029d
    s_mov_b64 exec, vcc
    v_lshlrev_b32_sdwa v22, 3, v180 dst_sel:DWORD dst_unused:UNUSED_PAD src0_sel:DWORD src1_sel:WORD_0
    v_add_u32 v22, v22, v24
    s_mov_b32 s29, 0
    buffer_load_dwordx4 v[80:83], v22, s[8:11], s29 offen offset:256 sc1
    s_waitcnt vmcnt(0)
    v_xor_b32 v80, s24, v80
    v_xor_b32 v81, s25, v81
    v_xor_b32 v82, s26, v82
    v_xor_b32 v83, s17, v83
    s_mov_b64 exec, -1
    s_branch K2_qf_8029l
K2_qf_8029d:
    v_xor_b32 v84, s24, v84
    v_xor_b32 v85, s25, v85
    v_xor_b32 v86, s26, v86
    v_xor_b32 v87, s17, v87
    v_cmp_gt_u32_sdwa s[76:77], v181, v228 src0_sel:WORD_1 src1_sel:DWORD
    s_mov_b32 s78, 200000
K2_qf_8030l:
    v_or_b32 v189, v84, v86
    v_or_b32 v190, v85, v87
    v_bfi_b32 v189, v188, v190, v189
    v_cmp_lt_u32 vcc, 0x1ff, v189
    s_and_b64 vcc, vcc, s[76:77]
    s_cbranch_scc0 K2_qf_8030d
    s_sub_u32 s78, s78, 1
    s_cbranch_scc1 K2_qf_8030d
    s_mov_b64 exec, vcc
    v_lshlrev_b32_sdwa v22, 3, v181 dst_sel:DWORD dst_unused:UNUSED_PAD src0_sel:DWORD src1_sel:WORD_0
    v_add_u32 v22, v22, v24
    s_mov_b32 s29, 218112
    buffer_load_dwordx4 v[84:87], v22, s[8:11], s29 offen offset:256 sc1
    s_waitcnt vmcnt(0)
    v_xor_b32 v84, s24, v84
    v_xor_b32 v85, s25, v85
    v_xor_b32 v86, s26, v86
    v_xor_b32 v87, s17, v87
    s_mov_b64 exec, -1
    s_branch K2_qf_8030l
K2_qf_8030d:
    v_xor_b32 v104, s24, v104
    v_xor_b32 v105, s25, v105
    v_xor_b32 v106, s26, v106
    v_xor_b32 v107, s17, v107
    v_cmp_gt_u32_sdwa s[76:77], v182, v228 src0_sel:WORD_1 src1_sel:DWORD
    s_mov_b32 s78, 200000
K2_qf_8031l:
    v_or_b32 v189, v104, v106
    v_or_b32 v190, v105, v107
    v_bfi_b32 v189, v188, v190, v189
    v_cmp_lt_u32 vcc, 0x1ff, v189
    s_and_b64 vcc, vcc, s[76:77]
    s_cbranch_scc0 K2_qf_8031d
    s_sub_u32 s78, s78, 1
    s_cbranch_scc1 K2_qf_8031d
    s_mov_b64 exec, vcc
    v_lshlrev_b32_sdwa v22, 3, v182 dst_sel:DWORD dst_unused:UNUSED_PAD src0_sel:DWORD src1_sel:WORD_0
    v_add_u32 v22, v22, v24
    s_mov_b32 s29, 436224
    buffer_load_dwordx4 v[104:107], v22, s[8:11], s29 offen offset:256 sc1
    s_waitcnt vmcnt(0)
    v_xor_b32 v104, s24, v104
    v_xor_b32 v105, s25, v105
    v_xor_b32 v106, s26, v106
    v_xor_b32 v107, s17, v107
    s_mov_b64 exec, -1
    s_branch K2_qf_8031l
K2_qf_8031d:
    v_xor_b32 v108, s24, v108
    v_xor_b32 v109, s25, v109
    v_xor_b32 v110, s26, v110
    v_xor_b32 v111, s17, v111
    v_cmp_gt_u32_sdwa s[76:77], v183, v228 src0_sel:WORD_1 src1_sel:DWORD
    s_mov_b32 s78, 200000
K2_qf_8032l:
    v_or_b32 v189, v108, v110
    v_or_b32 v190, v109, v111
    v_bfi_b32 v189, v188, v190, v189
    v_cmp_lt_u32 vcc, 0x1ff, v189
    s_and_b64 vcc, vcc, s[76:77]
    s_cbranch_scc0 K2_qf_8032d
    s_sub_u32 s78, s78, 1
    s_cbranch_scc1 K2_qf_8032d
    s_mov_b64 exec, vcc
    v_lshlrev_b32_sdwa v22, 3, v183 dst_sel:DWORD dst_unused:UNUSED_PAD src0_sel:DWORD src1_sel:WORD_0
    v_add_u32 v22, v22, v24
    s_mov_b32 s29, 654336
    buffer_load_dwordx4 v[108:111], v22, s[8:11], s29 offen offset:256 sc1
    s_waitcnt vmcnt(0)
    v_xor_b32 v108, s24, v108
    v_xor_b32 v109, s25, v109
    v_xor_b32 v110, s26, v110
    v_xor_b32 v111, s17, v111
    s_mov_b64 exec, -1
    s_branch K2_qf_8032l
K2_qf_8032d:
K2_fx3_8028:
    s_branch K2_rare_3
    .p2align 6
K2_rare_4o:
    s_mov_b64 exec, s[64:65]
    v_lshlrev_b32_sdwa v100, 1, v141 dst_sel:DWORD dst_unused:UNUSED_PAD src0_sel:DWORD src1_sel:WORD_0
    ds_add_rtn_u32 v160, v100, v248
    s_mov_b64 exec, s[66:67]
    v_lshlrev_b32_sdwa v101, 1, v143 dst_sel:DWORD dst_unused:UNUSED_PAD src0_sel:DWORD src1_sel:WORD_0
    ds_add_rtn_u32 v161, v101, v248
    s_mov_b64 exec, s[68:69]
    v_lshlrev_b32_sdwa v102, 1, v145 dst_sel:DWORD dst_unused:UNUSED_PAD src0_sel:DWORD src1_sel:WORD_0
    ds_add_rtn_u32 v162, v102, v248
    s_mov_b64 exec, s[70:71]
    v_lshlrev_b32_sdwa v103, 1, v147 dst_sel:DWORD dst_unused:UNUSED_PAD src0_sel:DWORD src1_sel:WORD_0
    ds_add_rtn_u32 v163, v103, v248
    s_mov_b64 exec, -1
    s_branch K2_rare_4
    .p2align 6
K2_rare_5o:
    v_cmp_gt_u32_sdwa vcc, v180, v228 src0_sel:WORD_1 src1_sel:DWORD
    s_nop 1
    v_cndmask_b32 v81, -1, v81, vcc
    v_cmp_gt_u32_sdwa vcc, v180, v229 src0_sel:WORD_1 src1_sel:DWORD
    s_nop 1
    v_cndmask_b32 v83, -1, v83, vcc
    v_cmp_gt_u32_sdwa vcc, v181, v228 src0_sel:WORD_1 src1_sel:DWORD
    s_nop 1
    v_cndmask_b32 v85, -1, v85, vcc
    v_cmp_gt_u32_sdwa vcc, v181, v229 src0_sel:WORD_1 src1_sel:DWORD
    s_nop 1
    v_cndmask_b32 v87, -1, v87, vcc
    v_cmp_gt_u32_sdwa vcc, v182, v228 src0_sel:WORD_1 src1_sel:DWORD
    s_nop 1
    v_cndmask_b32 v105, -1, v105, vcc
    v_cmp_gt_u32_sdwa vcc, v182, v229 src0_sel:WORD_1 src1_sel:DWORD
    s_nop 1
    v_cndmask_b32 v107, -1, v107, vcc
    v_cmp_gt_u32_sdwa vcc, v183, v228 src0_sel:WORD_1 src1_sel:DWORD
    s_nop 1
    v_cndmask_b32 v109, -1, v109, vcc
    v_cmp_gt_u32_sdwa vcc, v183, v229 src0_sel:WORD_1 src1_sel:DWORD
    s_nop 1
    v_cndmask_b32 v111, -1, v111, vcc
    s_branch K2_rare_5
    .p2align 6
K2_rare_6o:
    v_cmp_ne_u32 vcc, -1, v81
    s_mov_b64 exec, vcc
    v_lshlrev_b32_sdwa v192, 1, v81 dst_sel:DWORD dst_unused:UNUSED_PAD src0_sel:DWORD src1_sel:WORD_0
    ds_add_rtn_u32 v184, v192, v248
    s_mov_b64 exec, -1
    v_cmp_ne_u32 vcc, -1, v83
    s_mov_b64 exec, vcc
    v_lshlrev_b32_sdwa v193, 1, v83 dst_sel:DWORD dst_unused:UNUSED_PAD src0_sel:DWORD src1_sel:WORD_0
    ds_add_rtn_u32 v185, v193, v248
    s_mov_b64 exec, -1
    v_cmp_ne_u32 vcc, -1, v85
    s_mov_b64 exec, vcc
    v_lshlrev_b32_sdwa v194, 1, v85 dst_sel:DWORD dst_unused:UNUSED_PAD src0_sel:DWORD src1_sel:WORD_0
    ds_add_rtn_u32 v186, v194, v248
    s_mov_b64 exec, -1
    v_cmp_ne_u32 vcc, -1, v87
    s_mov_b64 exec, vcc
    v_lshlrev_b32_sdwa v195, 1, v87 dst_sel:DWORD dst_unused:UNUSED_PAD src0_sel:DWORD src1_sel:WORD_0
    ds_add_rtn_u32 v187, v195, v248
    s_mov_b64 exec, -1
    v_cmp_ne_u32 vcc, -1, v105
    s_mov_b64 exec, vcc
    v_lshlrev_b32_sdwa v112, 1, v105 dst_sel:DWORD dst_unused:UNUSED_PAD src0_sel:DWORD src1_sel:WORD_0
    ds_add_rtn_u32 v188, v112, v248
    s_mov_b64 exec, -1
    v_cmp_ne_u32 vcc, -1, v107
    s_mov_b64 exec, vcc
    v_lshlrev_b32_sdwa v113, 1, v107 dst_sel:DWORD dst_unused:UNUSED_PAD src0_sel:DWORD src1_sel:WORD_0
    ds_add_rtn_u32 v189, v113, v248
    s_mov_b64 exec, -1
    v_cmp_ne_u32 vcc, -1, v109
    s_mov_b64 exec, vcc
    v_lshlrev_b32_sdwa v114, 1, v109 dst_sel:DWORD dst_unused:UNUSED_PAD src0_sel:DWORD src1_sel:WORD_0
    ds_add_rtn_u32 v190, v114, v248
    s_mov_b64 exec, -1
    v_cmp_ne_u32 vcc, -1, v111
    s_mov_b64 exec, vcc
    v_lshlrev_b32_sdwa v115, 1, v111 dst_sel:DWORD dst_unused:UNUSED_PAD src0_sel:DWORD src1_sel:WORD_0
    ds_add_rtn_u32 v191, v115, v248
    s_mov_b64 exec, -1
    s_branch K2_rare_6
    .p2align 6
K2_rare_7o:
    ds_read_b32 v100, v100 offset:1024
    ds_read_b32 v101, v101 offset:1024
    ds_read_b32 v102, v102 offset:1024
    ds_read_b32 v103, v103 offset:1024
    s_mov_b64 exec, -1
    s_branch K2_rare_7
    .p2align 6
K2_rare_8o:
    v_cmp_ne_u32 vcc, -1, v81
    s_mov_b64 exec, vcc
    ds_read_b32 v192, v192 offset:1024
    s_mov_b64 exec, -1
    v_cmp_ne_u32 vcc, -1, v83
    s_mov_b64 exec, vcc
    ds_read_b32 v193, v193 offset:1024
    s_mov_b64 exec, -1
    v_cmp_ne_u32 vcc, -1, v85
    s_mov_b64 exec, vcc
    ds_read_b32 v194, v194 offset:1024
    s_mov_b64 exec, -1
    v_cmp_ne_u32 vcc, -1, v87
    s_mov_b64 exec, vcc
    ds_read_b32 v195, v195 offset:1024
    s_mov_b64 exec, -1
    v_cmp_ne_u32 vcc, -1, v105
    s_mov_b64 exec, vcc
    ds_read_b32 v112, v112 offset:1024
    s_mov_b64 exec, -1
    v_cmp_ne_u32 vcc, -1, v107
    s_mov_b64 exec, vcc
    ds_read_b32 v113, v113 offset:1024
    s_mov_b64 exec, -1
    v_cmp_ne_u32 vcc, -1, v109
    s_mov_b64 exec, vcc
    ds_read_b32 v114, v114 offset:1024
    s_mov_b64 exec, -1
    v_cmp_ne_u32 vcc, -1, v111
    s_mov_b64 exec, vcc
    ds_read_b32 v115, v115 offset:1024
    s_mov_b64 exec, -1
    s_branch K2_rare_8
    .p2align 6
K2_rare_9o:
    v_cmp_gt_u32 vcc, s79, v180
    v_cmp_gt_u32 s[74:75], s79, v181
    v_cmp_gt_u32 s[34:35], s79, v182
    v_cmp_gt_u32 s[76:77], s79, v183
    s_bcnt1_i32_b64 s78, vcc
    s_bcnt1_i32_b64 s39, s[74:75]
    s_bcnt1_i32_b64 s74, s[34:35]
    s_bcnt1_i32_b64 s75, s[76:77]
    s_add_u32 s78, s78, s39
    s_add_u32 s74, s74, s75
    s_add_u32 s78, s78, s74
    s_max_u32 s78, s78, 1
    s_lshl_b32 s78, s78, 2
    v_mov_b32 v24, s78
    ds_read_b32 v24, v24 offset:1020
    s_waitcnt lgkmcnt(0)
    v_readfirstlane_b32 s28, v24
    s_nop 3
    s_add_u32 s29, s28, 31
    s_and_b32 s29, s29, 0xffffffe0
    s_add_u32 s28, s28, 32
    s_cmp_le_u32 s28, s79
    s_cselect_b32 s29, s29, s79
    s_cmp_lt_u32 s79, s17
    s_cselect_b32 s79, s29, s79
    v_cmp_gt_u32 vcc, s3, v180
    v_cmp_gt_u32 s[74:75], s3, v181
    v_cmp_gt_u32 s[34:35], s3, v182
    v_cmp_gt_u32 s[76:77], s3, v183
    s_bcnt1_i32_b64 s78, vcc
    s_bcnt1_i32_b64 s39, s[74:75]
    s_bcnt1_i32_b64 s74, s[34:35]
    s_bcnt1_i32_b64 s75, s[76:77]
    s_add_u32 s78, s78, s39
    s_add_u32 s74, s74, s75
    s_add_u32 s78, s78, s74
    s_max_u32 s78, s78, 1
    s_lshl_b32 s78, s78, 2
    v_mov_b32 v24, s78
    ds_read_b32 v24, v24 offset:1020
    s_waitcnt lgkmcnt(0)
    v_readfirstlane_b32 s28, v24
    s_nop 3
    s_add_u32 s29, s28, 31
    s_and_b32 s29, s29, 0xffffffe0
    s_add_u32 s28, s28, 32
    s_cmp_le_u32 s28, s3
    s_cselect_b32 s29, s29, s3
    s_cmp_lt_u32 s3, s17
    s_cselect_b32 s3, s29, s3
    s_branch K2_rare_9
    .p2align 6
K2_oldmode:
    s_mul_i32 s28, s22, s17
    s_mul_i32 s29, s27, s17
    s_lshr_b32 s28, s28, 8
    s_lshr_b32 s29, s29, 8
    v_cmp_gt_u32 vcc, s28, v180
    v_cmp_gt_u32 s[74:75], s28, v181
    v_cmp_gt_u32 s[34:35], s28, v182
    v_cmp_gt_u32 s[76:77], s28, v183
    s_bcnt1_i32_b64 s79, vcc
    s_bcnt1_i32_b64 s39, s[74:75]
    s_bcnt1_i32_b64 s74, s[34:35]
    s_bcnt1_i32_b64 s75, s[76:77]
    s_add_u32 s79, s79, s39
    s_add_u32 s74, s74, s75
    s_add_u32 s79, s79, s74
    v_cmp_gt_u32 vcc, s29, v180
    v_cmp_gt_u32 s[74:75], s29, v181
    v_cmp_gt_u32 s[34:35], s29, v182
    v_cmp_gt_u32 s[76:77], s29, v183
    s_bcnt1_i32_b64 s78, vcc
    s_bcnt1_i32_b64 s39, s[74:75]
    s_bcnt1_i32_b64 s74, s[34:35]
    s_bcnt1_i32_b64 s75, s[76:77]
    s_add_u32 s78, s78, s39
    s_add_u32 s74, s74, s75
    s_add_u32 s78, s78, s74
    s_lshl_b32 s28, s79, 2
    s_lshl_b32 s29, s78, 2
    v_mov_b32 v24, s28
    v_mov_b32 v25, s29
    ds_read_b32 v24, v24 offset:1024
    ds_read_b32 v25, v25 offset:1024
    s_waitcnt lgkmcnt(0)
    v_readfirstlane_b32 s79, v24
    v_readfirstlane_b32 s3, v25
    s_branch K2_ranges
    .p2align 6
K2_rare_10o:
    s_mov_b64 exec, s[64:65]
    v_add_lshl_u32 v100, v100, v160, 3
    ds_write_b64 v100, v[140:141] offset:56832
    s_mov_b64 exec, s[66:67]
    v_add_lshl_u32 v101, v101, v161, 3
    ds_write_b64 v101, v[142:143] offset:56832
    s_mov_b64 exec, s[68:69]
    v_add_lshl_u32 v102, v102, v162, 3
    ds_write_b64 v102, v[144:145] offset:56832
    s_mov_b64 exec, s[70:71]
    v_add_lshl_u32 v103, v103, v163, 3
    ds_write_b64 v103, v[146:147] offset:56832
    s_mov_b64 exec, -1
    s_branch K2_rare_10
    .p2align 6
K2_rare_11o:
    v_cmp_ne_u32 vcc, -1, v81
    s_mov_b64 exec, vcc
    v_add_lshl_u32 v192, v192, v184, 3
    ds_write_b64 v192, v[80:81] offset:56832
    s_mov_b64 exec, -1
    v_cmp_ne_u32 vcc, -1, v83
    s_mov_b64 exec, vcc
    v_add_lshl_u32 v193, v193, v185, 3
    ds_write_b64 v193, v[82:83] offset:56832
    s_mov_b64 exec, -1
    v_cmp_ne_u32 vcc, -1, v85
    s_mov_b64 exec, vcc
    v_add_lshl_u32 v194, v194, v186, 3
    ds_write_b64 v194, v[84:85] offset:56832
    s_mov_b64 exec, -1
    v_cmp_ne_u32 vcc, -1, v87
    s_mov_b64 exec, vcc
    v_add_lshl_u32 v195, v195, v187, 3
    ds_write_b64 v195, v[86:87] offset:56832
    s_mov_b64 exec, -1
    v_cmp_ne_u32 vcc, -1, v105
    s_mov_b64 exec, vcc
    v_add_lshl_u32 v112, v112, v188, 3
    ds_write_b64 v112, v[104:105] offset:56832
    s_mov_b64 exec, -1
    v_cmp_ne_u32 vcc, -1, v107
    s_mov_b64 exec, vcc
    v_add_lshl_u32 v113, v113, v189, 3
    ds_write_b64 v113, v[106:107] offset:56832
    s_mov_b64 exec, -1
    v_cmp_ne_u32 vcc, -1, v109
    s_mov_b64 exec, vcc
    v_add_lshl_u32 v114, v114, v190, 3
    ds_write_b64 v114, v[108:109] offset:56832
    s_mov_b64 exec, -1
    v_cmp_ne_u32 vcc, -1, v111
    s_mov_b64 exec, vcc
    v_add_lshl_u32 v115, v115, v191, 3
    ds_write_b64 v115, v[110:111] offset:56832
    s_mov_b64 exec, -1
    s_branch K2_rare_11
    .p2align 6
K2_san_14o:
    s_max_i32 s28, s42, 0
    v_cmp_gt_u32 s[74:75], s28, v1
    v_mov_b32 v229, s44
    s_nop 0
    v_cndmask_b32 v218, v19, v218, s[74:75]
    v_cndmask_b32 v219, v19, v219, s[74:75]
    v_cndmask_b32 v221, v19, v221, s[74:75]
    v_cndmask_b32 v222, v229, v222, s[74:75]
    v_mov_b32 v223, v222
    s_nop 0
    s_branch K2_san_14
K2_gen:
    s_mov_b32 s25, 0
    buffer_load_dwordx2 v[214:215], v212, s[52:55], 0 idxen
    v_lshlrev_b32_sdwa v231, 3, v213 dst_sel:DWORD dst_unused:UNUSED_PAD src0_sel:DWORD src1_sel:WORD_0
    ds_read_b96 v[228:230], v231 offset:53248
K2g_loop:
    s_waitcnt vmcnt(0)
    ds_read_b128 v[88:91], v2
    ds_read_b128 v[92:95], v3
    ds_read_b128 v[96:99], v4
    ds_read_b128 v[100:103], v5
    ds_read_b32 v250, v8 offset:0
    ds_read_b32 v252, v8 offset:64
    ds_read_b32 v254, v8 offset:128
    ds_read_b32 v6, v8 offset:192
    v_add_u32 v8, 256, v8
    v_readlane_b32 s21, v18, s20
    s_waitcnt lgkmcnt(0)
    buffer_load_dwordx4 v[250:251], s[4:7], 0 idxen offen offset:0 lds
    buffer_load_dwordx4 v[252:253], s[4:7], 0 idxen offen offset:1024 lds
    buffer_load_dwordx4 v[254:255], s[4:7], 0 idxen offen offset:2048 lds
    buffer_load_dwordx4 v[6:7], s[4:7], 0 idxen offen offset:3072 lds
    s_and_b32 s22, s21, 0xffff
    s_bfe_u32 s23, s21, 0xf0010
    s_mov_b32 s27, s22
    s_cmp_eq_u32 s25, 0
    s_cbranch_scc1 K2g_A_open
    s_add_u32 s28, s24, 16
    s_cmp_lt_u32 s23, s28
    s_cbranch_scc1 K2g_A_body
    s_cmp_eq_u32 s22, s24
    s_cbranch_scc1 K2g_A_body
K2g_A_pass:
    s_mov_b32 s40, s24
    s_nop 7
    s_nop 7
    ds_read_b128 v[196:199], v23 offset:0
    ds_read_b128 v[200:203], v23 offset:16
    ds_read_b128 v[204:207], v23 offset:32
    ds_read_b128 v[208:211], v23 offset:48
    v_cvt_pk_bf16_f32 v180, v148, v149
    v_cvt_pk_bf16_f32 v181, v150, v151
    s_lshr_b32 s28, s40, 1
    v_cvt_pk_bf16_f32 v182, v152, v153
    v_cvt_pk_bf16_f32 v183, v154, v155
    s_mul_i32 s29, s28, 136
    v_cvt_pk_bf16_f32 v184, v156, v157
    v_cvt_pk_bf16_f32 v185, v158, v159
    s_lshl_b32 s39, s28, 4
    s_waitcnt lgkmcnt(0)
    v_mfma_f32_32x32x16_bf16 v[116:131], v[196:199], v[180:183], 0
    v_cvt_pk_bf16_f32 v186, v160, v161
    s_sub_u32 s28, s78, s28
    v_cvt_pk_bf16_f32 v187, v162, v163
    s_min_u32 s28, s28, 8
    v_cvt_pk_bf16_f32 v188, v164, v165
    v_cvt_pk_bf16_f32 v189, v166, v167
    s_bfm_b32 s28, s28, 0
    v_mfma_f32_32x32x16_bf16 v[116:131], v[200:203], v[184:187], v[116:131]
    v_cvt_pk_bf16_f32 v190, v168, v169
    v_cvt_pk_bf16_f32 v191, v170, v171
    v_cvt_pk_bf16_f32 v192, v172, v173
    v_cvt_pk_bf16_f32 v193, v174, v175
    v_mfma_f32_32x32x16_bf16 v[116:131], v[204:207], v[188:191], v[116:131]
    v_cvt_pk_bf16_f32 v194, v176, v177
    v_cvt_pk_bf16_f32 v195, v178, v179
    v_add_u32 v20, s29, v16
    s_mov_b64 exec, s[56:57]
    v_add_u32 v20, s58, v16
    s_mov_b64 exec, -1
    v_add_u32 v21, s39, v17
    s_add_u32 s60, s29, 85760
    s_cmp_lg_u32 s56, 0
    s_cselect_b32 s60, s59, s60
    s_mov_b64 s[56:57], 0
    s_mul_i32 s29, s28, 0x01010100
    v_mfma_f32_32x32x16_bf16 v[116:131], v[208:211], v[192:195], v[116:131]
    v_mfma_f32_32x32x16_bf16 v[148:163], v[28:31], v[28:31], 0
    v_mfma_f32_32x32x16_bf16 v[164:179], v[28:31], v[28:31], 0
    s_mov_b32 exec_lo, s28
    s_mov_b32 exec_hi, s28
    ds_write2_b64 v20, v[180:181], v[182:183] offset0:0 offset1:2
    ds_write2_b64 v20, v[184:185], v[186:187] offset0:4 offset1:6
    ds_write2_b64 v20, v[188:189], v[190:191] offset0:8 offset1:10
    ds_write2_b64 v20, v[192:193], v[194:195] offset0:12 offset1:14
    s_mov_b64 exec, -1
    s_or_b32 s76, s29, 1
    s_mov_b32 s77, 0
    s_mov_b32 s43, 0
    s_nop 7
    v_writelane_b32 v116, s60, 0
    s_mov_b64 exec, s[76:77]
    ds_write_b32 v21, v116
    s_mov_b64 exec, -1
    s_mov_b64 s[76:77], 0
K2g_A_open:
    s_mov_b32 s24, s27
    s_mov_b32 s25, 1
    s_lshr_b32 s28, s24, 1
    v_mad_u32_u24 v20, v15, s28, v14
    v_subrev_u32 v11, s24, v10
    ds_read_b64_tr_b16 v[80:81], v20 offset:0
    ds_read_b64_tr_b16 v[82:83], v20 offset:544
    ds_read_b64_tr_b16 v[84:85], v20 offset:64
    ds_read_b64_tr_b16 v[86:87], v20 offset:608
K2g_A_body:
    v_add_u32_sdwa v26, v11, v222 dst_sel:DWORD dst_unused:UNUSED_PAD src0_sel:DWORD src1_sel:WORD_0
    v_sub_u32 v21, v26, v10
    v_cmp_gt_u32 s[74:75], 16, v21
    s_nop 1
    s_mov_b64 exec, s[74:75]
    ds_write_b16 v26, v218
    ds_write_b16_d16_hi v26, v218 offset:16
    s_mov_b64 exec, -1
    ds_read_b128 v[104:107], v12
    ds_read_b64_tr_b16 v[108:109], v13 offset:0
    ds_read_b64_tr_b16 v[110:111], v13 offset:640
    ds_read_b64_tr_b16 v[112:113], v13 offset:1280
    ds_read_b64_tr_b16 v[114:115], v13 offset:1920
    s_mov_b64 exec, s[74:75]
    ds_write_b16 v26, v19
    ds_write_b16 v26, v19 offset:16
    s_mov_b64 exec, -1
    s_waitcnt lgkmcnt(0)
    v_cndmask_b32 v104, v104, v220, s[30:31]
    s_nop 1
    v_mfma_f32_32x32x16_bf16 v[116:131], v[88:91], v[32:35], 0
    v_mfma_f32_32x32x16_bf16 v[116:131], v[92:95], v[36:39], v[116:131]
    v_mfma_f32_32x32x16_bf16 v[116:131], v[96:99], v[40:43], v[116:131]
    v_mfma_f32_32x32x16_bf16 v[116:131], v[100:103], v[44:47], v[116:131]
    v_mfma_f32_32x32x16_bf16 v[116:131], v[104:107], v[80:83], v[116:131]
    v_mfma_f32_32x32x16_bf16 v[132:147], v[88:91], v[48:51], 0
    v_mfma_f32_32x32x16_bf16 v[132:147], v[92:95], v[52:55], v[132:147]
    v_mfma_f32_32x32x16_bf16 v[132:147], v[96:99], v[56:59], v[132:147]
    v_mfma_f32_32x32x16_bf16 v[132:147], v[100:103], v[60:63], v[132:147]
    v_mfma_f32_32x32x16_bf16 v[132:147], v[104:107], v[84:87], v[132:147]
    s_nop 7
    s_nop 7
    v_exp_f32 v180, v116
    v_exp_f32 v181, v117
    v_exp_f32 v182, v118
    v_exp_f32 v183, v119
    v_exp_f32 v184, v120
    v_exp_f32 v185, v121
    v_exp_f32 v186, v122
    v_exp_f32 v187, v123
    v_exp_f32 v188, v124
    v_exp_f32 v189, v125
    v_exp_f32 v190, v126
    v_exp_f32 v191, v127
    v_exp_f32 v192, v128
    v_exp_f32 v193, v129
    v_exp_f32 v194, v130
    v_exp_f32 v195, v131
    v_pk_add_f32 v[180:181], v[180:181], 1.0 op_sel_hi:[1,0]
    v_pk_add_f32 v[182:183], v[182:183], 1.0 op_sel_hi:[1,0]
    v_pk_add_f32 v[184:185], v[184:185], 1.0 op_sel_hi:[1,0]
    v_pk_add_f32 v[186:187], v[186:187], 1.0 op_sel_hi:[1,0]
    v_pk_add_f32 v[188:189], v[188:189], 1.0 op_sel_hi:[1,0]
    v_pk_add_f32 v[190:191], v[190:191], 1.0 op_sel_hi:[1,0]
    v_pk_add_f32 v[192:193], v[192:193], 1.0 op_sel_hi:[1,0]
    v_pk_add_f32 v[194:195], v[194:195], 1.0 op_sel_hi:[1,0]
    v_rcp_f32 v180, v180
    v_rcp_f32 v181, v181
    v_rcp_f32 v182, v182
    v_rcp_f32 v183, v183
    v_rcp_f32 v184, v184
    v_rcp_f32 v185, v185
    v_rcp_f32 v186, v186
    v_rcp_f32 v187, v187
    v_rcp_f32 v188, v188
    v_rcp_f32 v189, v189
    v_rcp_f32 v190, v190
    v_rcp_f32 v191, v191
    v_rcp_f32 v192, v192
    v_rcp_f32 v193, v193
    v_rcp_f32 v194, v194
    v_rcp_f32 v195, v195
    v_pk_mul_f32 v[180:181], v[180:181], v[116:117]
    v_pk_mul_f32 v[182:183], v[182:183], v[118:119]
    v_pk_mul_f32 v[184:185], v[184:185], v[120:121]
    v_pk_mul_f32 v[186:187], v[186:187], v[122:123]
    v_pk_mul_f32 v[188:189], v[188:189], v[124:125]
    v_pk_mul_f32 v[190:191], v[190:191], v[126:127]
    v_pk_mul_f32 v[192:193], v[192:193], v[128:129]
    v_pk_mul_f32 v[194:195], v[194:195], v[130:131]
    v_cvt_pk_bf16_f32 v196, v180, v181
    v_cvt_pk_bf16_f32 v197, v182, v183
    v_cvt_pk_bf16_f32 v198, v184, v185
    v_cvt_pk_bf16_f32 v199, v186, v187
    v_cvt_pk_bf16_f32 v200, v188, v189
    v_cvt_pk_bf16_f32 v201, v190, v191
    v_cvt_pk_bf16_f32 v202, v192, v193
    v_cvt_pk_bf16_f32 v203, v194, v195
    v_exp_f32 v180, v132
    v_exp_f32 v181, v133
    v_exp_f32 v182, v134
    v_exp_f32 v183, v135
    v_exp_f32 v184, v136
    v_exp_f32 v185, v137
    v_exp_f32 v186, v138
    v_exp_f32 v187, v139
    v_exp_f32 v188, v140
    v_exp_f32 v189, v141
    v_exp_f32 v190, v142
    v_exp_f32 v191, v143
    v_exp_f32 v192, v144
    v_exp_f32 v193, v145
    v_exp_f32 v194, v146
    v_exp_f32 v195, v147
    v_pk_add_f32 v[180:181], v[180:181], 1.0 op_sel_hi:[1,0]
    v_pk_add_f32 v[182:183], v[182:183], 1.0 op_sel_hi:[1,0]
    v_pk_add_f32 v[184:185], v[184:185], 1.0 op_sel_hi:[1,0]
    v_pk_add_f32 v[186:187], v[186:187], 1.0 op_sel_hi:[1,0]
    v_pk_add_f32 v[188:189], v[188:189], 1.0 op_sel_hi:[1,0]
    v_pk_add_f32 v[190:191], v[190:191], 1.0 op_sel_hi:[1,0]
    v_pk_add_f32 v[192:193], v[192:193], 1.0 op_sel_hi:[1,0]
    v_pk_add_f32 v[194:195], v[194:195], 1.0 op_sel_hi:[1,0]
    v_rcp_f32 v180, v180
    v_rcp_f32 v181, v181
    v_rcp_f32 v182, v182
    v_rcp_f32 v183, v183
    v_rcp_f32 v184, v184
    v_rcp_f32 v185, v185
    v_rcp_f32 v186, v186
    v_rcp_f32 v187, v187
    v_rcp_f32 v188, v188
    v_rcp_f32 v189, v189
    v_rcp_f32 v190, v190
    v_rcp_f32 v191, v191
    v_rcp_f32 v192, v192
    v_rcp_f32 v193, v193
    v_rcp_f32 v194, v194
    v_rcp_f32 v195, v195
    v_pk_mul_f32 v[180:181], v[180:181], v[132:133]
    v_pk_mul_f32 v[182:183], v[182:183], v[134:135]
    v_pk_mul_f32 v[184:185], v[184:185], v[136:137]
    v_pk_mul_f32 v[186:187], v[186:187], v[138:139]
    v_pk_mul_f32 v[188:189], v[188:189], v[140:141]
    v_pk_mul_f32 v[190:191], v[190:191], v[142:143]
    v_pk_mul_f32 v[192:193], v[192:193], v[144:145]
    v_pk_mul_f32 v[194:195], v[194:195], v[146:147]
    v_cvt_pk_bf16_f32 v204, v180, v181
    v_cvt_pk_bf16_f32 v205, v182, v183
    v_cvt_pk_bf16_f32 v206, v184, v185
    v_cvt_pk_bf16_f32 v207, v186, v187
    v_cvt_pk_bf16_f32 v208, v188, v189
    v_cvt_pk_bf16_f32 v209, v190, v191
    v_cvt_pk_bf16_f32 v210, v192, v193
    v_cvt_pk_bf16_f32 v211, v194, v195
    s_nop 1
    v_mfma_f32_32x32x16_bf16 v[148:163], v[196:199], v[108:111], v[148:163]
    v_mfma_f32_32x32x16_bf16 v[164:179], v[204:207], v[108:111], v[164:179]
    v_mfma_f32_32x32x16_bf16 v[148:163], v[200:203], v[112:115], v[148:163]
    v_mfma_f32_32x32x16_bf16 v[164:179], v[208:211], v[112:115], v[164:179]
    s_add_u32 s27, s24, 16
    s_cmp_ge_u32 s23, s27
    s_cbranch_scc1 K2g_A_pass
    s_add_u32 s20, s20, 1
    s_cmp_ge_u32 s20, s19
    s_cbranch_scc1 K2g_fin
    s_waitcnt vmcnt(0)
    ds_read_b128 v[88:91], v2
    ds_read_b128 v[92:95], v3
    ds_read_b128 v[96:99], v4
    ds_read_b128 v[100:103], v5
    ds_read_b32 v250, v8 offset:0
    ds_read_b32 v252, v8 offset:64
    ds_read_b32 v254, v8 offset:128
    ds_read_b32 v6, v8 offset:192
    v_add_u32 v8, 256, v8
    v_readlane_b32 s21, v18, s20
    s_waitcnt lgkmcnt(0)
    buffer_load_dwordx4 v[250:251], s[4:7], 0 idxen offen offset:0 lds
    buffer_load_dwordx4 v[252:253], s[4:7], 0 idxen offen offset:1024 lds
    buffer_load_dwordx4 v[254:255], s[4:7], 0 idxen offen offset:2048 lds
    buffer_load_dwordx4 v[6:7], s[4:7], 0 idxen offen offset:3072 lds
    s_and_b32 s22, s21, 0xffff
    s_bfe_u32 s23, s21, 0xf0010
    s_mov_b32 s27, s22
    s_cmp_eq_u32 s25, 0
    s_cbranch_scc1 K2g_B_open
    s_add_u32 s28, s24, 16
    s_cmp_lt_u32 s23, s28
    s_cbranch_scc1 K2g_B_body
    s_cmp_eq_u32 s22, s24
    s_cbranch_scc1 K2g_B_body
K2g_B_pass:
    s_mov_b32 s40, s24
    s_nop 7
    s_nop 7
    ds_read_b128 v[196:199], v23 offset:0
    ds_read_b128 v[200:203], v23 offset:16
    ds_read_b128 v[204:207], v23 offset:32
    ds_read_b128 v[208:211], v23 offset:48
    v_cvt_pk_bf16_f32 v180, v148, v149
    v_cvt_pk_bf16_f32 v181, v150, v151
    s_lshr_b32 s28, s40, 1
    v_cvt_pk_bf16_f32 v182, v152, v153
    v_cvt_pk_bf16_f32 v183, v154, v155
    s_mul_i32 s29, s28, 136
    v_cvt_pk_bf16_f32 v184, v156, v157
    v_cvt_pk_bf16_f32 v185, v158, v159
    s_lshl_b32 s39, s28, 4
    s_waitcnt lgkmcnt(0)
    v_mfma_f32_32x32x16_bf16 v[116:131], v[196:199], v[180:183], 0
    v_cvt_pk_bf16_f32 v186, v160, v161
    s_sub_u32 s28, s78, s28
    v_cvt_pk_bf16_f32 v187, v162, v163
    s_min_u32 s28, s28, 8
    v_cvt_pk_bf16_f32 v188, v164, v165
    v_cvt_pk_bf16_f32 v189, v166, v167
    s_bfm_b32 s28, s28, 0
    v_mfma_f32_32x32x16_bf16 v[116:131], v[200:203], v[184:187], v[116:131]
    v_cvt_pk_bf16_f32 v190, v168, v169
    v_cvt_pk_bf16_f32 v191, v170, v171
    v_cvt_pk_bf16_f32 v192, v172, v173
    v_cvt_pk_bf16_f32 v193, v174, v175
    v_mfma_f32_32x32x16_bf16 v[116:131], v[204:207], v[188:191], v[116:131]
    v_cvt_pk_bf16_f32 v194, v176, v177
    v_cvt_pk_bf16_f32 v195, v178, v179
    v_add_u32 v20, s29, v16
    s_mov_b64 exec, s[56:57]
    v_add_u32 v20, s58, v16
    s_mov_b64 exec, -1
    v_add_u32 v21, s39, v17
    s_add_u32 s60, s29, 85760
    s_cmp_lg_u32 s56, 0
    s_cselect_b32 s60, s59, s60
    s_mov_b64 s[56:57], 0
    s_mul_i32 s29, s28, 0x01010100
    v_mfma_f32_32x32x16_bf16 v[116:131], v[208:211], v[192:195], v[116:131]
    v_mfma_f32_32x32x16_bf16 v[148:163], v[28:31], v[28:31], 0
    v_mfma_f32_32x32x16_bf16 v[164:179], v[28:31], v[28:31], 0
    s_mov_b32 exec_lo, s28
    s_mov_b32 exec_hi, s28
    ds_write2_b64 v20, v[180:181], v[182:183] offset0:0 offset1:2
    ds_write2_b64 v20, v[184:185], v[186:187] offset0:4 offset1:6
    ds_write2_b64 v20, v[188:189], v[190:191] offset0:8 offset1:10
    ds_write2_b64 v20, v[192:193], v[194:195] offset0:12 offset1:14
    s_mov_b64 exec, -1
    s_or_b32 s76, s29, 1
    s_mov_b32 s77, 0
    s_mov_b32 s43, 0
    s_nop 7
    v_writelane_b32 v116, s60, 0
    s_mov_b64 exec, s[76:77]
    ds_write_b32 v21, v116
    s_mov_b64 exec, -1
    s_mov_b64 s[76:77], 0
K2g_B_open:
    s_mov_b32 s24, s27
    s_mov_b32 s25, 1
    s_lshr_b32 s28, s24, 1
    v_mad_u32_u24 v20, v15, s28, v14
    v_subrev_u32 v11, s24, v10
    ds_read_b64_tr_b16 v[80:81], v20 offset:0
    ds_read_b64_tr_b16 v[82:83], v20 offset:544
    ds_read_b64_tr_b16 v[84:85], v20 offset:64
    ds_read_b64_tr_b16 v[86:87], v20 offset:608
K2g_B_body:
    v_add_u32_sdwa v26, v11, v223 dst_sel:DWORD dst_unused:UNUSED_PAD src0_sel:DWORD src1_sel:WORD_0
    v_sub_u32 v21, v26, v10
    v_cmp_gt_u32 s[74:75], 16, v21
    s_nop 1
    s_mov_b64 exec, s[74:75]
    ds_write_b16 v26, v219
    ds_write_b16_d16_hi v26, v219 offset:16
    s_mov_b64 exec, -1
    ds_read_b128 v[104:107], v12
    ds_read_b64_tr_b16 v[108:109], v13 offset:0
    ds_read_b64_tr_b16 v[110:111], v13 offset:640
    ds_read_b64_tr_b16 v[112:113], v13 offset:1280
    ds_read_b64_tr_b16 v[114:115], v13 offset:1920
    s_mov_b64 exec, s[74:75]
    ds_write_b16 v26, v19
    ds_write_b16 v26, v19 offset:16
    s_mov_b64 exec, -1
    s_waitcnt lgkmcnt(0)
    v_cndmask_b32 v104, v104, v221, s[30:31]
    s_nop 1
    v_mfma_f32_32x32x16_bf16 v[116:131], v[88:91], v[32:35], 0
    v_mfma_f32_32x32x16_bf16 v[116:131], v[92:95], v[36:39], v[116:131]
    v_mfma_f32_32x32x16_bf16 v[116:131], v[96:99], v[40:43], v[116:131]
    v_mfma_f32_32x32x16_bf16 v[116:131], v[100:103], v[44:47], v[116:131]
    v_mfma_f32_32x32x16_bf16 v[116:131], v[104:107], v[80:83], v[116:131]
    v_mfma_f32_32x32x16_bf16 v[132:147], v[88:91], v[48:51], 0
    v_mfma_f32_32x32x16_bf16 v[132:147], v[92:95], v[52:55], v[132:147]
    v_mfma_f32_32x32x16_bf16 v[132:147], v[96:99], v[56:59], v[132:147]
    v_mfma_f32_32x32x16_bf16 v[132:147], v[100:103], v[60:63], v[132:147]
    v_mfma_f32_32x32x16_bf16 v[132:147], v[104:107], v[84:87], v[132:147]
    s_nop 7
    s_nop 7
    v_exp_f32 v180, v116
    v_exp_f32 v181, v117
    v_exp_f32 v182, v118
    v_exp_f32 v183, v119
    v_exp_f32 v184, v120
    v_exp_f32 v185, v121
    v_exp_f32 v186, v122
    v_exp_f32 v187, v123
    v_exp_f32 v188, v124
    v_exp_f32 v189, v125
    v_exp_f32 v190, v126
    v_exp_f32 v191, v127
    v_exp_f32 v192, v128
    v_exp_f32 v193, v129
    v_exp_f32 v194, v130
    v_exp_f32 v195, v131
    v_pk_add_f32 v[180:181], v[180:181], 1.0 op_sel_hi:[1,0]
    v_pk_add_f32 v[182:183], v[182:183], 1.0 op_sel_hi:[1,0]
    v_pk_add_f32 v[184:185], v[184:185], 1.0 op_sel_hi:[1,0]
    v_pk_add_f32 v[186:187], v[186:187], 1.0 op_sel_hi:[1,0]
    v_pk_add_f32 v[188:189], v[188:189], 1.0 op_sel_hi:[1,0]
    v_pk_add_f32 v[190:191], v[190:191], 1.0 op_sel_hi:[1,0]
    v_pk_add_f32 v[192:193], v[192:193], 1.0 op_sel_hi:[1,0]
    v_pk_add_f32 v[194:195], v[194:195], 1.0 op_sel_hi:[1,0]
    v_rcp_f32 v180, v180
    v_rcp_f32 v181, v181
    v_rcp_f32 v182, v182
    v_rcp_f32 v183, v183
    v_rcp_f32 v184, v184
    v_rcp_f32 v185, v185
    v_rcp_f32 v186, v186
    v_rcp_f32 v187, v187
    v_rcp_f32 v188, v188
    v_rcp_f32 v189, v189
    v_rcp_f32 v190, v190
    v_rcp_f32 v191, v191
    v_rcp_f32 v192, v192
    v_rcp_f32 v193, v193
    v_rcp_f32 v194, v194
    v_rcp_f32 v195, v195
    v_pk_mul_f32 v[180:181], v[180:181], v[116:117]
    v_pk_mul_f32 v[182:183], v[182:183], v[118:119]
    v_pk_mul_f32 v[184:185], v[184:185], v[120:121]
    v_pk_mul_f32 v[186:187], v[186:187], v[122:123]
    v_pk_mul_f32 v[188:189], v[188:189], v[124:125]
    v_pk_mul_f32 v[190:191], v[190:191], v[126:127]
    v_pk_mul_f32 v[192:193], v[192:193], v[128:129]
    v_pk_mul_f32 v[194:195], v[194:195], v[130:131]
    v_cvt_pk_bf16_f32 v196, v180, v181
    v_cvt_pk_bf16_f32 v197, v182, v183
    v_cvt_pk_bf16_f32 v198, v184, v185
    v_cvt_pk_bf16_f32 v199, v186, v187
    v_cvt_pk_bf16_f32 v200, v188, v189
    v_cvt_pk_bf16_f32 v201, v190, v191
    v_cvt_pk_bf16_f32 v202, v192, v193
    v_cvt_pk_bf16_f32 v203, v194, v195
    v_exp_f32 v180, v132
    v_exp_f32 v181, v133
    v_exp_f32 v182, v134
    v_exp_f32 v183, v135
    v_exp_f32 v184, v136
    v_exp_f32 v185, v137
    v_exp_f32 v186, v138
    v_exp_f32 v187, v139
    v_exp_f32 v188, v140
    v_exp_f32 v189, v141
    v_exp_f32 v190, v142
    v_exp_f32 v191, v143
    v_exp_f32 v192, v144
    v_exp_f32 v193, v145
    v_exp_f32 v194, v146
    v_exp_f32 v195, v147
    v_pk_add_f32 v[180:181], v[180:181], 1.0 op_sel_hi:[1,0]
    v_pk_add_f32 v[182:183], v[182:183], 1.0 op_sel_hi:[1,0]
    v_pk_add_f32 v[184:185], v[184:185], 1.0 op_sel_hi:[1,0]
    v_pk_add_f32 v[186:187], v[186:187], 1.0 op_sel_hi:[1,0]
    v_pk_add_f32 v[188:189], v[188:189], 1.0 op_sel_hi:[1,0]
    v_pk_add_f32 v[190:191], v[190:191], 1.0 op_sel_hi:[1,0]
    v_pk_add_f32 v[192:193], v[192:193], 1.0 op_sel_hi:[1,0]
    v_pk_add_f32 v[194:195], v[194:195], 1.0 op_sel_hi:[1,0]
    v_rcp_f32 v180, v180
    v_rcp_f32 v181, v181
    v_rcp_f32 v182, v182
    v_rcp_f32 v183, v183
    v_rcp_f32 v184, v184
    v_rcp_f32 v185, v185
    v_rcp_f32 v186, v186
    v_rcp_f32 v187, v187
    v_rcp_f32 v188, v188
    v_rcp_f32 v189, v189
    v_rcp_f32 v190, v190
    v_rcp_f32 v191, v191
    v_rcp_f32 v192, v192
    v_rcp_f32 v193, v193
    v_rcp_f32 v194, v194
    v_rcp_f32 v195, v195
    v_pk_mul_f32 v[180:181], v[180:181], v[132:133]
    v_pk_mul_f32 v[182:183], v[182:183], v[134:135]
    v_pk_mul_f32 v[184:185], v[184:185], v[136:137]
    v_pk_mul_f32 v[186:187], v[186:187], v[138:139]
    v_pk_mul_f32 v[188:189], v[188:189], v[140:141]
    v_pk_mul_f32 v[190:191], v[190:191], v[142:143]
    v_pk_mul_f32 v[192:193], v[192:193], v[144:145]
    v_pk_mul_f32 v[194:195], v[194:195], v[146:147]
    v_cvt_pk_bf16_f32 v204, v180, v181
    v_cvt_pk_bf16_f32 v205, v182, v183
    v_cvt_pk_bf16_f32 v206, v184, v185
    v_cvt_pk_bf16_f32 v207, v186, v187
    v_cvt_pk_bf16_f32 v208, v188, v189
    v_cvt_pk_bf16_f32 v209, v190, v191
    v_cvt_pk_bf16_f32 v210, v192, v193
    v_cvt_pk_bf16_f32 v211, v194, v195
    s_nop 1
    v_mfma_f32_32x32x16_bf16 v[148:163], v[196:199], v[108:111], v[148:163]
    v_mfma_f32_32x32x16_bf16 v[164:179], v[204:207], v[108:111], v[164:179]
    v_mfma_f32_32x32x16_bf16 v[148:163], v[200:203], v[112:115], v[148:163]
    v_mfma_f32_32x32x16_bf16 v[164:179], v[208:211], v[112:115], v[164:179]
    s_add_u32 s27, s24, 16
    s_cmp_ge_u32 s23, s27
    s_cbranch_scc1 K2g_B_pass
    s_add_u32 s20, s20, 1
    s_cmp_ge_u32 s20, s19
    s_cbranch_scc1 K2g_fin
    v_mov_b32 v222, v213
    v_mov_b32 v223, v213
    ds_read_b64 v[212:213], v9
    v_add_u32 v9, 512, v9
    v_lshlrev_b32 v224, 16, v214
    v_and_b32 v225, 0xffff0000, v214
    v_lshlrev_b32 v226, 16, v215
    v_sub_f32 v224, v228, v224
    v_sub_f32 v225, v229, v225
    v_sub_f32 v226, v230, v226
    v_cvt_pk_bf16_f32 v218, v27, v224
    v_cvt_pk_bf16_f32 v219, v225, v226
    v_and_b32 v227, 0xffff0000, v218
    v_mul_f32 v227, v227, v227
    v_dot2_f32_bf16 v227, v219, v219, v227
    s_nop 2
    v_cvt_pk_bf16_f32 v221, v227, v227
    v_bfi_b32 v221, s45, v221, v222
    s_cmp_lt_i32 s42, 64
    s_cbranch_scc1 K2_san_8033o
K2_san_8033:
    s_sub_i32 s42, s42, 64
    s_nop 1
    v_permlane32_swap_b32 v218, v219
    v_permlane32_swap_b32 v222, v223
    v_permlane32_swap_b32 v220, v221
    s_waitcnt lgkmcnt(0)
    buffer_load_dwordx2 v[214:215], v212, s[52:55], 0 idxen
    v_lshlrev_b32_sdwa v231, 3, v213 dst_sel:DWORD dst_unused:UNUSED_PAD src0_sel:DWORD src1_sel:WORD_0
    ds_read_b96 v[228:230], v231 offset:53248
    s_branch K2g_loop
K2g_fin:
    s_mov_b32 s40, s24
    s_nop 7
    s_nop 7
    ds_read_b128 v[196:199], v23 offset:0
    ds_read_b128 v[200:203], v23 offset:16
    ds_read_b128 v[204:207], v23 offset:32
    ds_read_b128 v[208:211], v23 offset:48
    v_cvt_pk_bf16_f32 v180, v148, v149
    v_cvt_pk_bf16_f32 v181, v150, v151
    s_lshr_b32 s28, s40, 1
    v_cvt_pk_bf16_f32 v182, v152, v153
    v_cvt_pk_bf16_f32 v183, v154, v155
    s_mul_i32 s29, s28, 136
    v_cvt_pk_bf16_f32 v184, v156, v157
    v_cvt_pk_bf16_f32 v185, v158, v159
    s_lshl_b32 s39, s28, 4
    s_waitcnt lgkmcnt(0)
    v_mfma_f32_32x32x16_bf16 v[116:131], v[196:199], v[180:183], 0
    v_cvt_pk_bf16_f32 v186, v160, v161
    s_sub_u32 s28, s78, s28
    v_cvt_pk_bf16_f32 v187, v162, v163
    s_min_u32 s28, s28, 8
    v_cvt_pk_bf16_f32 v188, v164, v165
    v_cvt_pk_bf16_f32 v189, v166, v167
    s_bfm_b32 s28, s28, 0
    v_mfma_f32_32x32x16_bf16 v[116:131], v[200:203], v[184:187], v[116:131]
    v_cvt_pk_bf16_f32 v190, v168, v169
    v_cvt_pk_bf16_f32 v191, v170, v171
    v_cvt_pk_bf16_f32 v192, v172, v173
    v_cvt_pk_bf16_f32 v193, v174, v175
    v_mfma_f32_32x32x16_bf16 v[116:131], v[204:207], v[188:191], v[116:131]
    v_cvt_pk_bf16_f32 v194, v176, v177
    v_cvt_pk_bf16_f32 v195, v178, v179
    v_add_u32 v20, s29, v16
    s_mov_b64 exec, s[56:57]
    v_add_u32 v20, s58, v16
    s_mov_b64 exec, -1
    v_add_u32 v21, s39, v17
    s_add_u32 s60, s29, 85760
    s_cmp_lg_u32 s56, 0
    s_cselect_b32 s60, s59, s60
    s_mov_b64 s[56:57], 0
    s_mul_i32 s29, s28, 0x01010100
    v_mfma_f32_32x32x16_bf16 v[116:131], v[208:211], v[192:195], v[116:131]
    s_mov_b32 exec_lo, s28
    s_mov_b32 exec_hi, s28
    ds_write2_b64 v20, v[180:181], v[182:183] offset0:0 offset1:2
    ds_write2_b64 v20, v[184:185], v[186:187] offset0:4 offset1:6
    ds_write2_b64 v20, v[188:189], v[190:191] offset0:8 offset1:10
    ds_write2_b64 v20, v[192:193], v[194:195] offset0:12 offset1:14
    s_mov_b64 exec, -1
    s_or_b32 s76, s29, 1
    s_mov_b32 s77, 0
    s_mov_b32 s43, 0
    s_nop 7
    v_writelane_b32 v116, s60, 0
    s_mov_b64 exec, s[76:77]
    ds_write_b32 v21, v116
    s_mov_b64 exec, -1
    s_mov_b64 s[76:77], 0
    s_waitcnt vmcnt(0)
    s_cmp_eq_u32 s16, 7
    s_cbranch_scc1 K2_fh_8034
    v_lshlrev_b32 v31, 4, v1
    s_mov_b32 s28, 7118848
    buffer_load_dwordx4 v[32:35], v31, s[8:11], s28 offen offset:0
    buffer_load_dwordx4 v[36:39], v31, s[8:11], s28 offen offset:1024
    buffer_load_dwordx4 v[40:43], v31, s[8:11], s28 offen offset:2048
    buffer_load_dwordx4 v[44:47], v31, s[8:11], s28 offen offset:3072
    s_mov_b32 s28, 7122944
    buffer_load_dwordx4 v[48:51], v31, s[8:11], s28 offen offset:0
    buffer_load_dwordx4 v[52:55], v31, s[8:11], s28 offen offset:1024
    buffer_load_dwordx4 v[56:59], v31, s[8:11], s28 offen offset:2048
    buffer_load_dwordx4 v[60:63], v31, s[8:11], s28 offen offset:3072
K2_fh_8034:
    s_branch K2_u1
    .p2align 6
K2_san_8033o:
    s_max_i32 s28, s42, 0
    v_cmp_gt_u32 s[74:75], s28, v1
    v_mov_b32 v229, s44
    s_nop 0
    v_cndmask_b32 v218, v19, v218, s[74:75]
    v_cndmask_b32 v219, v19, v219, s[74:75]
    v_cndmask_b32 v221, v19, v221, s[74:75]
    v_cndmask_b32 v222, v229, v222, s[74:75]
    v_mov_b32 v223, v222
    s_nop 0
    s_branch K2_san_8033
K2_slow:
    v_mov_b32 v22, 2080
    ds_read_b64 v[22:23], v22
    s_waitcnt vmcnt(0) lgkmcnt(0)
    v_readfirstlane_b32 s54, v22
    v_readfirstlane_b32 s55, v23
    s_nop 3
    s_lshl_b32 s48, s54, 16
    s_lshr_b32 s49, s54, 7
    s_and_b32 s49, s49, 0xfe00
    s_mul_i32 s51, s54, 0x9e3779b1
    s_add_u32 s51, s51, s55
    s_and_b32 s50, s51, 0xffff0000
    s_and_b32 s51, s51, 0xfe00
    s_mov_b32 s56, s32
    s_or_b32 s57, s33, 393216
    s_mov_b32 s58, 50000
    s_mov_b32 s59, 0x20000
    s_cmp_eq_u32 s16, 7
    s_cbranch_scc1 K2_noard_8035
    s_waitcnt vmcnt(0)
    v_xor_b32 v224, 0, v30
    ds_read_b64 v[232:233], v224
    v_xor_b32 v224, 16, v30
    ds_read_b64 v[234:235], v224
    v_xor_b32 v224, 32, v30
    ds_read_b64 v[236:237], v224
    v_xor_b32 v224, 48, v30
    ds_read_b64 v[238:239], v224
    v_xor_b32 v224, 64, v30
    ds_read_b64 v[240:241], v224
    v_xor_b32 v224, 80, v30
    ds_read_b64 v[242:243], v224
    v_xor_b32 v224, 96, v30
    ds_read_b64 v[244:245], v224
    v_xor_b32 v224, 112, v30
    ds_read_b64 v[246:247], v224
K2_noard_8035:
    s_cmp_eq_u32 s16, 7
    s_cbranch_scc1 K2_noatab_8036
    s_mov_b32 s28, 3216550459
    s_mov_b32 s29, 3216550459
    v_mul_u32_u24 v225, 136, v28
    v_lshl_add_u32 v225, v29, 3, v225
    v_add_u32 v225, s73, v225
    s_waitcnt lgkmcnt(0)
    v_mfma_f32_32x32x16_bf16 v[88:103], v[196:199], v[232:235], 0
    v_mfma_f32_32x32x16_bf16 v[88:103], v[200:203], v[236:239], v[88:103]
    v_mfma_f32_32x32x16_bf16 v[88:103], v[204:207], v[240:243], v[88:103]
    v_mfma_f32_32x32x16_bf16 v[88:103], v[208:211], v[244:247], v[88:103]
    v_mfma_f32_32x32x16_bf16 v[116:131], v[164:167], v[232:235], 0
    v_mfma_f32_32x32x16_bf16 v[116:131], v[168:171], v[236:239], v[116:131]
    v_mfma_f32_32x32x16_bf16 v[116:131], v[172:175], v[240:243], v[116:131]
    v_mfma_f32_32x32x16_bf16 v[116:131], v[176:179], v[244:247], v[116:131]
    s_nop 7
    s_nop 3
    v_cvt_pk_bf16_f32 v88, v88, v89
    v_cvt_pk_bf16_f32 v89, v90, v91
    v_cvt_pk_bf16_f32 v90, v92, v93
    v_cvt_pk_bf16_f32 v91, v94, v95
    v_cvt_pk_bf16_f32 v92, v96, v97
    v_cvt_pk_bf16_f32 v93, v98, v99
    v_cvt_pk_bf16_f32 v94, v100, v101
    v_cvt_pk_bf16_f32 v95, v102, v103
    ds_write2_b64 v225, v[88:89], v[90:91] offset0:0 offset1:2
    ds_write2_b64 v225, v[92:93], v[94:95] offset0:4 offset1:6
    v_cvt_pk_bf16_f32 v116, v116, v117
    v_cvt_pk_bf16_f32 v117, v118, v119
    v_cvt_pk_bf16_f32 v118, v120, v121
    v_cvt_pk_bf16_f32 v119, v122, v123
    v_cvt_pk_bf16_f32 v120, v124, v125
    v_cvt_pk_bf16_f32 v121, v126, v127
    v_cvt_pk_bf16_f32 v122, v128, v129
    v_cvt_pk_bf16_f32 v123, v130, v131
    ds_write2_b64 v225, v[116:117], v[118:119] offset0:8 offset1:10
    ds_write2_b64 v225, v[120:121], v[122:123] offset0:12 offset1:14
K2_noatab_8036:
    s_waitcnt lgkmcnt(0)
    v_and_b32 v28, 31, v1
    v_lshrrev_b32 v29, 5, v1
    v_lshlrev_b32 v31, 4, v1
    v_lshlrev_b32 v30, 3, v29
    v_add_u32 v30, 116224, v30
    ds_read_b64 v[88:89], v30 offset:0
    ds_read_b64 v[92:93], v30 offset:16
    ds_read_b64 v[96:97], v30 offset:32
    ds_read_b64 v[100:101], v30 offset:48
    ds_read_b64 v[104:105], v30 offset:64
    ds_read_b64 v[108:109], v30 offset:80
    ds_read_b64 v[112:113], v30 offset:96
    ds_read_b64 v[116:117], v30 offset:112
    ds_read_b64 v[120:121], v30 offset:128
    ds_read_b64 v[124:125], v30 offset:144
    ds_read_b64 v[128:129], v30 offset:160
    ds_read_b64 v[132:133], v30 offset:176
    ds_read_b64 v[136:137], v30 offset:192
    ds_read_b64 v[140:141], v30 offset:208
    ds_read_b64 v[144:145], v30 offset:224
    ds_read_b64 v[148:149], v30 offset:240
    s_waitcnt lgkmcnt(0)
    v_lshlrev_b32 v90, 16, v89
    v_and_b32 v91, 0xffff0000, v89
    v_and_b32 v89, 0xffff0000, v88
    v_lshlrev_b32 v88, 16, v88
    v_lshlrev_b32 v94, 16, v93
    v_and_b32 v95, 0xffff0000, v93
    v_and_b32 v93, 0xffff0000, v92
    v_lshlrev_b32 v92, 16, v92
    v_lshlrev_b32 v98, 16, v97
    v_and_b32 v99, 0xffff0000, v97
    v_and_b32 v97, 0xffff0000, v96
    v_lshlrev_b32 v96, 16, v96
    v_lshlrev_b32 v102, 16, v101
    v_and_b32 v103, 0xffff0000, v101
    v_and_b32 v101, 0xffff0000, v100
    v_lshlrev_b32 v100, 16, v100
    v_lshlrev_b32 v106, 16, v105
    v_and_b32 v107, 0xffff0000, v105
    v_and_b32 v105, 0xffff0000, v104
    v_lshlrev_b32 v104, 16, v104
    v_lshlrev_b32 v110, 16, v109
    v_and_b32 v111, 0xffff0000, v109
    v_and_b32 v109, 0xffff0000, v108
    v_lshlrev_b32 v108, 16, v108
    v_lshlrev_b32 v114, 16, v113
    v_and_b32 v115, 0xffff0000, v113
    v_and_b32 v113, 0xffff0000, v112
    v_lshlrev_b32 v112, 16, v112
    v_lshlrev_b32 v118, 16, v117
    v_and_b32 v119, 0xffff0000, v117
    v_and_b32 v117, 0xffff0000, v116
    v_lshlrev_b32 v116, 16, v116
    v_lshlrev_b32 v122, 16, v121
    v_and_b32 v123, 0xffff0000, v121
    v_and_b32 v121, 0xffff0000, v120
    v_lshlrev_b32 v120, 16, v120
    v_lshlrev_b32 v126, 16, v125
    v_and_b32 v127, 0xffff0000, v125
    v_and_b32 v125, 0xffff0000, v124
    v_lshlrev_b32 v124, 16, v124
    v_lshlrev_b32 v130, 16, v129
    v_and_b32 v131, 0xffff0000, v129
    v_and_b32 v129, 0xffff0000, v128
    v_lshlrev_b32 v128, 16, v128
    v_lshlrev_b32 v134, 16, v133
    v_and_b32 v135, 0xffff0000, v133
    v_and_b32 v133, 0xffff0000, v132
    v_lshlrev_b32 v132, 16, v132
    v_lshlrev_b32 v138, 16, v137
    v_and_b32 v139, 0xffff0000, v137
    v_and_b32 v137, 0xffff0000, v136
    v_lshlrev_b32 v136, 16, v136
    v_lshlrev_b32 v142, 16, v141
    v_and_b32 v143, 0xffff0000, v141
    v_and_b32 v141, 0xffff0000, v140
    v_lshlrev_b32 v140, 16, v140
    v_lshlrev_b32 v146, 16, v145
    v_and_b32 v147, 0xffff0000, v145
    v_and_b32 v145, 0xffff0000, v144
    v_lshlrev_b32 v144, 16, v144
    v_lshlrev_b32 v150, 16, v149
    v_and_b32 v151, 0xffff0000, v149
    v_and_b32 v149, 0xffff0000, v148
    v_lshlrev_b32 v148, 16, v148
    v_lshlrev_b32 v152, 16, v64
    v_and_b32 v153, 0xffff0000, v64
    v_lshlrev_b32 v154, 16, v65
    v_and_b32 v155, 0xffff0000, v65
    v_lshlrev_b32 v156, 16, v66
    v_and_b32 v157, 0xffff0000, v66
    v_lshlrev_b32 v158, 16, v67
    v_and_b32 v159, 0xffff0000, v67
    v_lshlrev_b32 v160, 16, v68
    v_and_b32 v161, 0xffff0000, v68
    v_lshlrev_b32 v162, 16, v69
    v_and_b32 v163, 0xffff0000, v69
    v_lshlrev_b32 v164, 16, v70
    v_and_b32 v165, 0xffff0000, v70
    v_lshlrev_b32 v166, 16, v71
    v_and_b32 v167, 0xffff0000, v71
    v_lshlrev_b32 v168, 16, v72
    v_and_b32 v169, 0xffff0000, v72
    v_lshlrev_b32 v170, 16, v73
    v_and_b32 v171, 0xffff0000, v73
    v_lshlrev_b32 v172, 16, v74
    v_and_b32 v173, 0xffff0000, v74
    v_lshlrev_b32 v174, 16, v75
    v_and_b32 v175, 0xffff0000, v75
    v_lshlrev_b32 v176, 16, v76
    v_and_b32 v177, 0xffff0000, v76
    v_lshlrev_b32 v178, 16, v77
    v_and_b32 v179, 0xffff0000, v77
    v_lshlrev_b32 v180, 16, v78
    v_and_b32 v181, 0xffff0000, v78
    v_lshlrev_b32 v182, 16, v79
    v_and_b32 v183, 0xffff0000, v79
    s_barrier
    v_mov_b32 v24, 0
    v_mov_b32 v25, 0
    v_mov_b32 v26, 0
    v_mov_b32 v27, 0
    v_lshlrev_b32 v30, 4, v0
    ds_write_b128 v30, v[24:27] offset:0
    ds_write_b128 v30, v[24:27] offset:8192
    ds_write_b128 v30, v[24:27] offset:16384
    ds_write_b128 v30, v[24:27] offset:24576
    ds_write_b128 v30, v[24:27] offset:32768
    ds_write_b128 v30, v[24:27] offset:40960
    v_cmp_gt_u32 vcc, 64, v0
    s_and_saveexec_b64 s[34:35], vcc
    ds_write_b128 v30, v[24:27] offset:49152
    s_mov_b64 exec, s[34:35]
    v_cmp_gt_u32 vcc, 196, v0
    s_and_saveexec_b64 s[34:35], vcc
    ds_write_b128 v30, v[24:27] offset:56832
    s_mov_b64 exec, s[34:35]
    s_waitcnt lgkmcnt(0)
    s_barrier
    s_mov_b32 s40, s16
    s_mov_b32 s46, 0xffff0000
K2s_chunk:
    s_lshl_b32 s28, s98, 3
    s_mul_i32 s29, s40, 2176
    s_add_u32 s28, s28, s29
    s_add_u32 s28, s28, 7340032
    v_mov_b32 v24, 0
    buffer_load_dword v24, v24, s[8:11], s28 offen sc1
    s_waitcnt vmcnt(0)
    v_readfirstlane_b32 s42, v24
    s_nop 3
    s_and_b32 s42, s42, 0x0fff0fff
    s_and_b32 s41, s42, 0xffff
    s_lshr_b32 s42, s42, 16
    s_mov_b32 s43, 0
K2s_tile:
    s_cmp_ge_u32 s43, s42
    s_cbranch_scc1 K2s_next
    v_add_u32 v24, s43, v28
    v_cmp_gt_u32 s[44:45], s42, v24
    v_add_u32 v24, s41, v24
    v_lshlrev_b32 v24, 3, v24
    s_mul_i32 s28, s40, 27264
    v_bfe_u32 v25, v24, 3, 1
    v_cmp_eq_u32 vcc, 1, v25
    v_mov_b32 v26, s48
    v_mov_b32 v27, s50
    v_cndmask_b32 v26, v26, v27, vcc
    v_mov_b32 v27, s49
    v_mov_b32 v25, s51
    v_cndmask_b32 v27, v27, v25, vcc
    s_mov_b32 s29, 200000
    s_mov_b64 s[52:53], s[44:45]
K2s_look:
    s_mov_b64 exec, s[52:53]
    buffer_load_dwordx2 v[18:19], v24, s[8:11], s28 offen sc1
    s_waitcnt vmcnt(0)
    v_xor_b32 v18, v26, v18
    v_xor_b32 v19, v27, v19
    v_and_b32 v25, 0xffff, v19
    v_and_or_b32 v25, v18, s46, v25
    s_movk_i32 s39, 511
    v_cmp_lt_u32 s[52:53], s39, v25
    s_mov_b64 exec, -1
    s_sub_u32 s29, s29, 1
    s_cbranch_scc1 K2s_have
    s_cmp_lg_u64 s[52:53], 0
    s_cbranch_scc1 K2s_look
K2s_have:
    v_cndmask_b32 v18, 0, v18, s[44:45]
    v_cndmask_b32 v19, 0, v19, s[44:45]
    v_mov_b32 v24, v18
    v_lshlrev_b32 v25, 4, v29
    v_add_u32 v25, 3072, v25
    buffer_load_dwordx4 v[184:187], v[24:25], s[4:7], 0 idxen offen offset:0
    buffer_load_dwordx4 v[188:191], v[24:25], s[4:7], 0 idxen offen offset:32
    buffer_load_dwordx4 v[192:195], v[24:25], s[4:7], 0 idxen offen offset:64
    buffer_load_dwordx4 v[196:199], v[24:25], s[4:7], 0 idxen offen offset:96
    buffer_load_dwordx2 v[20:21], v18, s[56:59], 0 idxen
    v_and_b32 v27, 0xffff, v19
    v_mul_u32_u24 v26, 68, v27
    v_lshl_add_u32 v26, v29, 3, v26
    v_add_u32 v26, 85760, v26
    ds_read_b64 v[2:3], v26 offset:0
    ds_read_b64 v[4:5], v26 offset:16
    ds_read_b64 v[6:7], v26 offset:32
    ds_read_b64 v[8:9], v26 offset:48
    ds_read_b64 v[10:11], v26 offset:64
    ds_read_b64 v[12:13], v26 offset:80
    ds_read_b64 v[14:15], v26 offset:96
    ds_read_b64 v[16:17], v26 offset:112
    v_lshlrev_b32 v30, 3, v27
    ds_read_b96 v[24:26], v30 offset:53248
    s_waitcnt vmcnt(0) lgkmcnt(0)
    v_mfma_f32_32x32x16_bf16 v[200:215], v[32:35], v[184:187], 0
    v_mfma_f32_32x32x16_bf16 v[200:215], v[36:39], v[188:191], v[200:215]
    v_mfma_f32_32x32x16_bf16 v[200:215], v[40:43], v[192:195], v[200:215]
    v_mfma_f32_32x32x16_bf16 v[200:215], v[44:47], v[196:199], v[200:215]
    v_mfma_f32_32x32x16_bf16 v[216:231], v[48:51], v[184:187], 0
    v_mfma_f32_32x32x16_bf16 v[216:231], v[52:55], v[188:191], v[216:231]
    v_mfma_f32_32x32x16_bf16 v[216:231], v[56:59], v[192:195], v[216:231]
    v_mfma_f32_32x32x16_bf16 v[216:231], v[60:63], v[196:199], v[216:231]
    v_lshlrev_b32 v30, 16, v20
    v_sub_f32 v24, v24, v30
    v_and_b32 v30, s46, v20
    v_sub_f32 v25, v25, v30
    v_lshlrev_b32 v30, 16, v21
    v_sub_f32 v26, v26, v30
    v_cvt_pk_bf16_f32 v30, v24, v25
    v_cvt_pk_bf16_f32 v31, v26, v26
    v_lshlrev_b32 v24, 16, v30
    v_and_b32 v25, s46, v30
    v_lshlrev_b32 v26, 16, v31
    v_mul_f32 v30, v24, v24
    v_fma_f32 v30, v25, v25, v30
    v_fma_f32 v30, v26, v26, v30
    v_cvt_pk_bf16_f32 v30, v30, v30
    v_lshlrev_b32 v30, 16, v30
    v_and_b32 v31, s46, v19
    s_nop 7
    s_nop 7
    v_mov_b32 v20, 0
    v_lshlrev_b32 v22, 7, v27
    v_lshl_add_u32 v22, v29, 4, v22
    v_lshlrev_b32 v21, 16, v2
    v_add_f32 v200, v200, v21
    v_fma_f32 v200, v30, v88, v200
    v_fma_f32 v200, v31, v120, v200
    v_exp_f32 v21, v200
    s_nop 0
    v_add_f32 v21, 1.0, v21
    v_rcp_f32 v21, v21
    s_nop 0
    v_mul_f32 v200, v200, v21
    v_fma_f32 v20, v200, v152, v20
    v_and_b32 v21, s46, v2
    v_add_f32 v201, v201, v21
    v_fma_f32 v201, v30, v89, v201
    v_fma_f32 v201, v31, v121, v201
    v_exp_f32 v21, v201
    s_nop 0
    v_add_f32 v21, 1.0, v21
    v_rcp_f32 v21, v21
    s_nop 0
    v_mul_f32 v201, v201, v21
    v_fma_f32 v20, v201, v153, v20
    v_lshlrev_b32 v21, 16, v3
    v_add_f32 v202, v202, v21
    v_fma_f32 v202, v30, v90, v202
    v_fma_f32 v202, v31, v122, v202
    v_exp_f32 v21, v202
    s_nop 0
    v_add_f32 v21, 1.0, v21
    v_rcp_f32 v21, v21
    s_nop 0
    v_mul_f32 v202, v202, v21
    v_fma_f32 v20, v202, v154, v20
    v_and_b32 v21, s46, v3
    v_add_f32 v203, v203, v21
    v_fma_f32 v203, v30, v91, v203
    v_fma_f32 v203, v31, v123, v203
    v_exp_f32 v21, v203
    s_nop 0
    v_add_f32 v21, 1.0, v21
    v_rcp_f32 v21, v21
    s_nop 0
    v_mul_f32 v203, v203, v21
    v_fma_f32 v20, v203, v155, v20
    v_lshlrev_b32 v21, 16, v4
    v_add_f32 v204, v204, v21
    v_fma_f32 v204, v30, v92, v204
    v_fma_f32 v204, v31, v124, v204
    v_exp_f32 v21, v204
    s_nop 0
    v_add_f32 v21, 1.0, v21
    v_rcp_f32 v21, v21
    s_nop 0
    v_mul_f32 v204, v204, v21
    v_fma_f32 v20, v204, v156, v20
    v_and_b32 v21, s46, v4
    v_add_f32 v205, v205, v21
    v_fma_f32 v205, v30, v93, v205
    v_fma_f32 v205, v31, v125, v205
    v_exp_f32 v21, v205
    s_nop 0
    v_add_f32 v21, 1.0, v21
    v_rcp_f32 v21, v21
    s_nop 0
    v_mul_f32 v205, v205, v21
    v_fma_f32 v20, v205, v157, v20
    v_lshlrev_b32 v21, 16, v5
    v_add_f32 v206, v206, v21
    v_fma_f32 v206, v30, v94, v206
    v_fma_f32 v206, v31, v126, v206
    v_exp_f32 v21, v206
    s_nop 0
    v_add_f32 v21, 1.0, v21
    v_rcp_f32 v21, v21
    s_nop 0
    v_mul_f32 v206, v206, v21
    v_fma_f32 v20, v206, v158, v20
    v_and_b32 v21, s46, v5
    v_add_f32 v207, v207, v21
    v_fma_f32 v207, v30, v95, v207
    v_fma_f32 v207, v31, v127, v207
    v_exp_f32 v21, v207
    s_nop 0
    v_add_f32 v21, 1.0, v21
    v_rcp_f32 v21, v21
    s_nop 0
    v_mul_f32 v207, v207, v21
    v_fma_f32 v20, v207, v159, v20
    v_lshlrev_b32 v21, 16, v6
    v_add_f32 v208, v208, v21
    v_fma_f32 v208, v30, v96, v208
    v_fma_f32 v208, v31, v128, v208
    v_exp_f32 v21, v208
    s_nop 0
    v_add_f32 v21, 1.0, v21
    v_rcp_f32 v21, v21
    s_nop 0
    v_mul_f32 v208, v208, v21
    v_fma_f32 v20, v208, v160, v20
    v_and_b32 v21, s46, v6
    v_add_f32 v209, v209, v21
    v_fma_f32 v209, v30, v97, v209
    v_fma_f32 v209, v31, v129, v209
    v_exp_f32 v21, v209
    s_nop 0
    v_add_f32 v21, 1.0, v21
    v_rcp_f32 v21, v21
    s_nop 0
    v_mul_f32 v209, v209, v21
    v_fma_f32 v20, v209, v161, v20
    v_lshlrev_b32 v21, 16, v7
    v_add_f32 v210, v210, v21
    v_fma_f32 v210, v30, v98, v210
    v_fma_f32 v210, v31, v130, v210
    v_exp_f32 v21, v210
    s_nop 0
    v_add_f32 v21, 1.0, v21
    v_rcp_f32 v21, v21
    s_nop 0
    v_mul_f32 v210, v210, v21
    v_fma_f32 v20, v210, v162, v20
    v_and_b32 v21, s46, v7
    v_add_f32 v211, v211, v21
    v_fma_f32 v211, v30, v99, v211
    v_fma_f32 v211, v31, v131, v211
    v_exp_f32 v21, v211
    s_nop 0
    v_add_f32 v21, 1.0, v21
    v_rcp_f32 v21, v21
    s_nop 0
    v_mul_f32 v211, v211, v21
    v_fma_f32 v20, v211, v163, v20
    v_lshlrev_b32 v21, 16, v8
    v_add_f32 v212, v212, v21
    v_fma_f32 v212, v30, v100, v212
    v_fma_f32 v212, v31, v132, v212
    v_exp_f32 v21, v212
    s_nop 0
    v_add_f32 v21, 1.0, v21
    v_rcp_f32 v21, v21
    s_nop 0
    v_mul_f32 v212, v212, v21
    v_fma_f32 v20, v212, v164, v20
    v_and_b32 v21, s46, v8
    v_add_f32 v213, v213, v21
    v_fma_f32 v213, v30, v101, v213
    v_fma_f32 v213, v31, v133, v213
    v_exp_f32 v21, v213
    s_nop 0
    v_add_f32 v21, 1.0, v21
    v_rcp_f32 v21, v21
    s_nop 0
    v_mul_f32 v213, v213, v21
    v_fma_f32 v20, v213, v165, v20
    v_lshlrev_b32 v21, 16, v9
    v_add_f32 v214, v214, v21
    v_fma_f32 v214, v30, v102, v214
    v_fma_f32 v214, v31, v134, v214
    v_exp_f32 v21, v214
    s_nop 0
    v_add_f32 v21, 1.0, v21
    v_rcp_f32 v21, v21
    s_nop 0
    v_mul_f32 v214, v214, v21
    v_fma_f32 v20, v214, v166, v20
    v_and_b32 v21, s46, v9
    v_add_f32 v215, v215, v21
    v_fma_f32 v215, v30, v103, v215
    v_fma_f32 v215, v31, v135, v215
    v_exp_f32 v21, v215
    s_nop 0
    v_add_f32 v21, 1.0, v21
    v_rcp_f32 v21, v21
    s_nop 0
    v_mul_f32 v215, v215, v21
    v_fma_f32 v20, v215, v167, v20
    v_lshlrev_b32 v21, 16, v10
    v_add_f32 v216, v216, v21
    v_fma_f32 v216, v30, v104, v216
    v_fma_f32 v216, v31, v136, v216
    v_exp_f32 v21, v216
    s_nop 0
    v_add_f32 v21, 1.0, v21
    v_rcp_f32 v21, v21
    s_nop 0
    v_mul_f32 v216, v216, v21
    v_fma_f32 v20, v216, v168, v20
    v_and_b32 v21, s46, v10
    v_add_f32 v217, v217, v21
    v_fma_f32 v217, v30, v105, v217
    v_fma_f32 v217, v31, v137, v217
    v_exp_f32 v21, v217
    s_nop 0
    v_add_f32 v21, 1.0, v21
    v_rcp_f32 v21, v21
    s_nop 0
    v_mul_f32 v217, v217, v21
    v_fma_f32 v20, v217, v169, v20
    v_lshlrev_b32 v21, 16, v11
    v_add_f32 v218, v218, v21
    v_fma_f32 v218, v30, v106, v218
    v_fma_f32 v218, v31, v138, v218
    v_exp_f32 v21, v218
    s_nop 0
    v_add_f32 v21, 1.0, v21
    v_rcp_f32 v21, v21
    s_nop 0
    v_mul_f32 v218, v218, v21
    v_fma_f32 v20, v218, v170, v20
    v_and_b32 v21, s46, v11
    v_add_f32 v219, v219, v21
    v_fma_f32 v219, v30, v107, v219
    v_fma_f32 v219, v31, v139, v219
    v_exp_f32 v21, v219
    s_nop 0
    v_add_f32 v21, 1.0, v21
    v_rcp_f32 v21, v21
    s_nop 0
    v_mul_f32 v219, v219, v21
    v_fma_f32 v20, v219, v171, v20
    v_lshlrev_b32 v21, 16, v12
    v_add_f32 v220, v220, v21
    v_fma_f32 v220, v30, v108, v220
    v_fma_f32 v220, v31, v140, v220
    v_exp_f32 v21, v220
    s_nop 0
    v_add_f32 v21, 1.0, v21
    v_rcp_f32 v21, v21
    s_nop 0
    v_mul_f32 v220, v220, v21
    v_fma_f32 v20, v220, v172, v20
    v_and_b32 v21, s46, v12
    v_add_f32 v221, v221, v21
    v_fma_f32 v221, v30, v109, v221
    v_fma_f32 v221, v31, v141, v221
    v_exp_f32 v21, v221
    s_nop 0
    v_add_f32 v21, 1.0, v21
    v_rcp_f32 v21, v21
    s_nop 0
    v_mul_f32 v221, v221, v21
    v_fma_f32 v20, v221, v173, v20
    v_lshlrev_b32 v21, 16, v13
    v_add_f32 v222, v222, v21
    v_fma_f32 v222, v30, v110, v222
    v_fma_f32 v222, v31, v142, v222
    v_exp_f32 v21, v222
    s_nop 0
    v_add_f32 v21, 1.0, v21
    v_rcp_f32 v21, v21
    s_nop 0
    v_mul_f32 v222, v222, v21
    v_fma_f32 v20, v222, v174, v20
    v_and_b32 v21, s46, v13
    v_add_f32 v223, v223, v21
    v_fma_f32 v223, v30, v111, v223
    v_fma_f32 v223, v31, v143, v223
    v_exp_f32 v21, v223
    s_nop 0
    v_add_f32 v21, 1.0, v21
    v_rcp_f32 v21, v21
    s_nop 0
    v_mul_f32 v223, v223, v21
    v_fma_f32 v20, v223, v175, v20
    v_lshlrev_b32 v21, 16, v14
    v_add_f32 v224, v224, v21
    v_fma_f32 v224, v30, v112, v224
    v_fma_f32 v224, v31, v144, v224
    v_exp_f32 v21, v224
    s_nop 0
    v_add_f32 v21, 1.0, v21
    v_rcp_f32 v21, v21
    s_nop 0
    v_mul_f32 v224, v224, v21
    v_fma_f32 v20, v224, v176, v20
    v_and_b32 v21, s46, v14
    v_add_f32 v225, v225, v21
    v_fma_f32 v225, v30, v113, v225
    v_fma_f32 v225, v31, v145, v225
    v_exp_f32 v21, v225
    s_nop 0
    v_add_f32 v21, 1.0, v21
    v_rcp_f32 v21, v21
    s_nop 0
    v_mul_f32 v225, v225, v21
    v_fma_f32 v20, v225, v177, v20
    v_lshlrev_b32 v21, 16, v15
    v_add_f32 v226, v226, v21
    v_fma_f32 v226, v30, v114, v226
    v_fma_f32 v226, v31, v146, v226
    v_exp_f32 v21, v226
    s_nop 0
    v_add_f32 v21, 1.0, v21
    v_rcp_f32 v21, v21
    s_nop 0
    v_mul_f32 v226, v226, v21
    v_fma_f32 v20, v226, v178, v20
    v_and_b32 v21, s46, v15
    v_add_f32 v227, v227, v21
    v_fma_f32 v227, v30, v115, v227
    v_fma_f32 v227, v31, v147, v227
    v_exp_f32 v21, v227
    s_nop 0
    v_add_f32 v21, 1.0, v21
    v_rcp_f32 v21, v21
    s_nop 0
    v_mul_f32 v227, v227, v21
    v_fma_f32 v20, v227, v179, v20
    v_lshlrev_b32 v21, 16, v16
    v_add_f32 v228, v228, v21
    v_fma_f32 v228, v30, v116, v228
    v_fma_f32 v228, v31, v148, v228
    v_exp_f32 v21, v228
    s_nop 0
    v_add_f32 v21, 1.0, v21
    v_rcp_f32 v21, v21
    s_nop 0
    v_mul_f32 v228, v228, v21
    v_fma_f32 v20, v228, v180, v20
    v_and_b32 v21, s46, v16
    v_add_f32 v229, v229, v21
    v_fma_f32 v229, v30, v117, v229
    v_fma_f32 v229, v31, v149, v229
    v_exp_f32 v21, v229
    s_nop 0
    v_add_f32 v21, 1.0, v21
    v_rcp_f32 v21, v21
    s_nop 0
    v_mul_f32 v229, v229, v21
    v_fma_f32 v20, v229, v181, v20
    v_lshlrev_b32 v21, 16, v17
    v_add_f32 v230, v230, v21
    v_fma_f32 v230, v30, v118, v230
    v_fma_f32 v230, v31, v150, v230
    v_exp_f32 v21, v230
    s_nop 0
    v_add_f32 v21, 1.0, v21
    v_rcp_f32 v21, v21
    s_nop 0
    v_mul_f32 v230, v230, v21
    v_fma_f32 v20, v230, v182, v20
    v_and_b32 v21, s46, v17
    v_add_f32 v231, v231, v21
    v_fma_f32 v231, v30, v119, v231
    v_fma_f32 v231, v31, v151, v231
    v_exp_f32 v21, v231
    s_nop 0
    v_add_f32 v21, 1.0, v21
    v_rcp_f32 v21, v21
    s_nop 0
    v_mul_f32 v231, v231, v21
    v_fma_f32 v20, v231, v183, v20
    s_mov_b64 exec, s[44:45]
    ds_add_f32 v22, v200 offset:0
    ds_add_f32 v22, v201 offset:4
    ds_add_f32 v22, v202 offset:8
    ds_add_f32 v22, v203 offset:12
    ds_add_f32 v22, v204 offset:32
    ds_add_f32 v22, v205 offset:36
    ds_add_f32 v22, v206 offset:40
    ds_add_f32 v22, v207 offset:44
    ds_add_f32 v22, v208 offset:64
    ds_add_f32 v22, v209 offset:68
    ds_add_f32 v22, v210 offset:72
    ds_add_f32 v22, v211 offset:76
    ds_add_f32 v22, v212 offset:96
    ds_add_f32 v22, v213 offset:100
    ds_add_f32 v22, v214 offset:104
    ds_add_f32 v22, v215 offset:108
    ds_add_f32 v22, v216 offset:128
    ds_add_f32 v22, v217 offset:132
    ds_add_f32 v22, v218 offset:136
    ds_add_f32 v22, v219 offset:140
    ds_add_f32 v22, v220 offset:160
    ds_add_f32 v22, v221 offset:164
    ds_add_f32 v22, v222 offset:168
    ds_add_f32 v22, v223 offset:172
    ds_add_f32 v22, v224 offset:192
    ds_add_f32 v22, v225 offset:196
    ds_add_f32 v22, v226 offset:200
    ds_add_f32 v22, v227 offset:204
    ds_add_f32 v22, v228 offset:224
    ds_add_f32 v22, v229 offset:228
    ds_add_f32 v22, v230 offset:232
    ds_add_f32 v22, v231 offset:236
    v_lshlrev_b32 v23, 3, v27
    v_mul_f32 v24, v24, v20
    ds_add_f32 v23, v24 offset:56832
    v_mul_f32 v25, v25, v20
    ds_add_f32 v23, v25 offset:56836
    v_mul_f32 v26, v26, v20
    ds_add_f32 v23, v26 offset:56840
    s_mov_b64 exec, -1
    s_waitcnt lgkmcnt(0)
    s_add_u32 s43, s43, 32
    s_branch K2s_tile
K2s_next:
    s_add_u32 s40, s40, 8
    s_cmp_lt_u32 s40, 256
    s_cbranch_scc1 K2s_chunk
    s_waitcnt lgkmcnt(0)
    s_barrier
    v_add_u32 v24, 0, v0
    s_movk_i32 s28, 6272
    v_cmp_gt_u32 vcc, s28, v24
    s_and_saveexec_b64 s[34:35], vcc
    v_lshlrev_b32 v25, 3, v24
    ds_read_b64 v[26:27], v25 offset:0
    v_lshrrev_b32 v25, 5, v24
    v_mul_u32_u24 v25, 136, v25
    v_and_b32 v24, 31, v24
    v_lshl_add_u32 v25, v24, 2, v25
    v_add_u32 v25, 117312, v25
    s_waitcnt lgkmcnt(0)
    v_cvt_pk_bf16_f32 v26, v26, v27
    ds_write_b32 v25, v26
    s_mov_b64 exec, s[34:35]
    v_add_u32 v24, 512, v0
    s_movk_i32 s28, 6272
    v_cmp_gt_u32 vcc, s28, v24
    s_and_saveexec_b64 s[34:35], vcc
    v_lshlrev_b32 v25, 3, v24
    ds_read_b64 v[26:27], v25 offset:0
    v_lshrrev_b32 v25, 5, v24
    v_mul_u32_u24 v25, 136, v25
    v_and_b32 v24, 31, v24
    v_lshl_add_u32 v25, v24, 2, v25
    v_add_u32 v25, 117312, v25
    s_waitcnt lgkmcnt(0)
    v_cvt_pk_bf16_f32 v26, v26, v27
    ds_write_b32 v25, v26
    s_mov_b64 exec, s[34:35]
    v_add_u32 v24, 1024, v0
    s_movk_i32 s28, 6272
    v_cmp_gt_u32 vcc, s28, v24
    s_and_saveexec_b64 s[34:35], vcc
    v_lshlrev_b32 v25, 3, v24
    ds_read_b64 v[26:27], v25 offset:0
    v_lshrrev_b32 v25, 5, v24
    v_mul_u32_u24 v25, 136, v25
    v_and_b32 v24, 31, v24
    v_lshl_add_u32 v25, v24, 2, v25
    v_add_u32 v25, 117312, v25
    s_waitcnt lgkmcnt(0)
    v_cvt_pk_bf16_f32 v26, v26, v27
    ds_write_b32 v25, v26
    s_mov_b64 exec, s[34:35]
    v_add_u32 v24, 1536, v0
    s_movk_i32 s28, 6272
    v_cmp_gt_u32 vcc, s28, v24
    s_and_saveexec_b64 s[34:35], vcc
    v_lshlrev_b32 v25, 3, v24
    ds_read_b64 v[26:27], v25 offset:0
    v_lshrrev_b32 v25, 5, v24
    v_mul_u32_u24 v25, 136, v25
    v_and_b32 v24, 31, v24
    v_lshl_add_u32 v25, v24, 2, v25
    v_add_u32 v25, 117312, v25
    s_waitcnt lgkmcnt(0)
    v_cvt_pk_bf16_f32 v26, v26, v27
    ds_write_b32 v25, v26
    s_mov_b64 exec, s[34:35]
    v_add_u32 v24, 2048, v0
    s_movk_i32 s28, 6272
    v_cmp_gt_u32 vcc, s28, v24
    s_and_saveexec_b64 s[34:35], vcc
    v_lshlrev_b32 v25, 3, v24
    ds_read_b64 v[26:27], v25 offset:0
    v_lshrrev_b32 v25, 5, v24
    v_mul_u32_u24 v25, 136, v25
    v_and_b32 v24, 31, v24
    v_lshl_add_u32 v25, v24, 2, v25
    v_add_u32 v25, 117312, v25
    s_waitcnt lgkmcnt(0)
    v_cvt_pk_bf16_f32 v26, v26, v27
    ds_write_b32 v25, v26
    s_mov_b64 exec, s[34:35]
    v_add_u32 v24, 2560, v0
    s_movk_i32 s28, 6272
    v_cmp_gt_u32 vcc, s28, v24
    s_and_saveexec_b64 s[34:35], vcc
    v_lshlrev_b32 v25, 3, v24
    ds_read_b64 v[26:27], v25 offset:0
    v_lshrrev_b32 v25, 5, v24
    v_mul_u32_u24 v25, 136, v25
    v_and_b32 v24, 31, v24
    v_lshl_add_u32 v25, v24, 2, v25
    v_add_u32 v25, 117312, v25
    s_waitcnt lgkmcnt(0)
    v_cvt_pk_bf16_f32 v26, v26, v27
    ds_write_b32 v25, v26
    s_mov_b64 exec, s[34:35]
    v_add_u32 v24, 3072, v0
    s_movk_i32 s28, 6272
    v_cmp_gt_u32 vcc, s28, v24
    s_and_saveexec_b64 s[34:35], vcc
    v_lshlrev_b32 v25, 3, v24
    ds_read_b64 v[26:27], v25 offset:0
    v_lshrrev_b32 v25, 5, v24
    v_mul_u32_u24 v25, 136, v25
    v_and_b32 v24, 31, v24
    v_lshl_add_u32 v25, v24, 2, v25
    v_add_u32 v25, 117312, v25
    s_waitcnt lgkmcnt(0)
    v_cvt_pk_bf16_f32 v26, v26, v27
    ds_write_b32 v25, v26
    s_mov_b64 exec, s[34:35]
    v_add_u32 v24, 3584, v0
    s_movk_i32 s28, 6272
    v_cmp_gt_u32 vcc, s28, v24
    s_and_saveexec_b64 s[34:35], vcc
    v_lshlrev_b32 v25, 3, v24
    ds_read_b64 v[26:27], v25 offset:0
    v_lshrrev_b32 v25, 5, v24
    v_mul_u32_u24 v25, 136, v25
    v_and_b32 v24, 31, v24
    v_lshl_add_u32 v25, v24, 2, v25
    v_add_u32 v25, 117312, v25
    s_waitcnt lgkmcnt(0)
    v_cvt_pk_bf16_f32 v26, v26, v27
    ds_write_b32 v25, v26
    s_mov_b64 exec, s[34:35]
    v_add_u32 v24, 4096, v0
    s_movk_i32 s28, 6272
    v_cmp_gt_u32 vcc, s28, v24
    s_and_saveexec_b64 s[34:35], vcc
    v_lshlrev_b32 v25, 3, v24
    ds_read_b64 v[26:27], v25 offset:0
    v_lshrrev_b32 v25, 5, v24
    v_mul_u32_u24 v25, 136, v25
    v_and_b32 v24, 31, v24
    v_lshl_add_u32 v25, v24, 2, v25
    v_add_u32 v25, 117312, v25
    s_waitcnt lgkmcnt(0)
    v_cvt_pk_bf16_f32 v26, v26, v27
    ds_write_b32 v25, v26
    s_mov_b64 exec, s[34:35]
    v_add_u32 v24, 4608, v0
    s_movk_i32 s28, 6272
    v_cmp_gt_u32 vcc, s28, v24
    s_and_saveexec_b64 s[34:35], vcc
    v_lshlrev_b32 v25, 3, v24
    ds_read_b64 v[26:27], v25 offset:0
    v_lshrrev_b32 v25, 5, v24
    v_mul_u32_u24 v25, 136, v25
    v_and_b32 v24, 31, v24
    v_lshl_add_u32 v25, v24, 2, v25
    v_add_u32 v25, 117312, v25
    s_waitcnt lgkmcnt(0)
    v_cvt_pk_bf16_f32 v26, v26, v27
    ds_write_b32 v25, v26
    s_mov_b64 exec, s[34:35]
    v_add_u32 v24, 5120, v0
    s_movk_i32 s28, 6272
    v_cmp_gt_u32 vcc, s28, v24
    s_and_saveexec_b64 s[34:35], vcc
    v_lshlrev_b32 v25, 3, v24
    ds_read_b64 v[26:27], v25 offset:0
    v_lshrrev_b32 v25, 5, v24
    v_mul_u32_u24 v25, 136, v25
    v_and_b32 v24, 31, v24
    v_lshl_add_u32 v25, v24, 2, v25
    v_add_u32 v25, 117312, v25
    s_waitcnt lgkmcnt(0)
    v_cvt_pk_bf16_f32 v26, v26, v27
    ds_write_b32 v25, v26
    s_mov_b64 exec, s[34:35]
    v_add_u32 v24, 5632, v0
    s_movk_i32 s28, 6272
    v_cmp_gt_u32 vcc, s28, v24
    s_and_saveexec_b64 s[34:35], vcc
    v_lshlrev_b32 v25, 3, v24
    ds_read_b64 v[26:27], v25 offset:0
    v_lshrrev_b32 v25, 5, v24
    v_mul_u32_u24 v25, 136, v25
    v_and_b32 v24, 31, v24
    v_lshl_add_u32 v25, v24, 2, v25
    v_add_u32 v25, 117312, v25
    s_waitcnt lgkmcnt(0)
    v_cvt_pk_bf16_f32 v26, v26, v27
    ds_write_b32 v25, v26
    s_mov_b64 exec, s[34:35]
    v_add_u32 v24, 6144, v0
    s_movk_i32 s28, 6272
    v_cmp_gt_u32 vcc, s28, v24
    s_and_saveexec_b64 s[34:35], vcc
    v_lshlrev_b32 v25, 3, v24
    ds_read_b64 v[26:27], v25 offset:0
    v_lshrrev_b32 v25, 5, v24
    v_mul_u32_u24 v25, 136, v25
    v_and_b32 v24, 31, v24
    v_lshl_add_u32 v25, v24, 2, v25
    v_add_u32 v25, 117312, v25
    s_waitcnt lgkmcnt(0)
    v_cvt_pk_bf16_f32 v26, v26, v27
    ds_write_b32 v25, v26
    s_mov_b64 exec, s[34:35]
    v_cmp_gt_u32 vcc, 196, v0
    s_and_saveexec_b64 s[34:35], vcc
    v_lshlrev_b32 v25, 4, v0
    ds_read_b128 v[8:11], v25 offset:56832
    v_add_u32 v25, 145056, v25
    s_waitcnt lgkmcnt(0)
    ds_write_b32 v25, v8 offset:4
    ds_write_b32 v25, v9 offset:8
    ds_write_b32 v25, v10 offset:12
    s_mov_b64 exec, s[34:35]
    s_cmp_eq_u32 s16, 7
    s_cbranch_scc1 K2_fh_8037
    v_lshlrev_b32 v31, 4, v1
    s_mov_b32 s28, 7118848
    buffer_load_dwordx4 v[32:35], v31, s[8:11], s28 offen offset:0
    buffer_load_dwordx4 v[36:39], v31, s[8:11], s28 offen offset:1024
    buffer_load_dwordx4 v[40:43], v31, s[8:11], s28 offen offset:2048
    buffer_load_dwordx4 v[44:47], v31, s[8:11], s28 offen offset:3072
    s_mov_b32 s28, 7122944
    buffer_load_dwordx4 v[48:51], v31, s[8:11], s28 offen offset:0
    buffer_load_dwordx4 v[52:55], v31, s[8:11], s28 offen offset:1024
    buffer_load_dwordx4 v[56:59], v31, s[8:11], s28 offen offset:2048
    buffer_load_dwordx4 v[60:63], v31, s[8:11], s28 offen offset:3072
K2_fh_8037:
    s_branch K2_u1
K2_end:
    s_endpgm
.section .rodata,"a"
.p2align 6
.amdhsa_kernel gather_scatter__cheap_equivariant_egnn__graph_kernel
  .amdhsa_next_free_vgpr 256
  .amdhsa_next_free_sgpr 102
  .amdhsa_accum_offset 256
  .amdhsa_group_segment_fixed_size 0
  .amdhsa_kernarg_size 88
  .amdhsa_user_sgpr_count 2
  .amdhsa_user_sgpr_kernarg_segment_ptr 1
  .amdhsa_system_sgpr_workgroup_id_x 1
.end_amdhsa_kernel
```
